```python
import torch

def _softmax(x, axis=-1):
    return torch.softmax(x, dim=axis)
def _gelu(x):
    return torch.nn.functional.gelu(x, approximate="tanh")
def _silu(x):
    return torch.nn.functional.silu(x)
def _sigmoid(x):
    return torch.sigmoid(x)
def _layernorm(x, axis=-1, eps=1e-5):
    m = x.mean(dim=axis, keepdim=True)
    v = x.var(dim=axis, keepdim=True, unbiased=False)
    return (x - m) / torch.sqrt(v + eps)
def _scatter_add(tgt, idx, src, axis=0):
    return tgt.clone().index_add_(axis, idx, src)
def _segment_sum(src, seg, n):
    out = torch.zeros((n,) + src.shape[1:], dtype=src.dtype)
    return out.index_add_(0, seg, src)
def _pad(x, pw):
    flat = tuple(v for pair in reversed(pw) for v in pair)
    return torch.nn.functional.pad(x, flat)

kernel_name = 'sequential_preLN__ssm_conv_s4__swiglu_ffn__prompt'

def setup_inputs():

    _w = (lambda a: (lambda t: t.to(torch.bfloat16) if t.is_floating_point() else t)(torch.as_tensor(a)))
    def _A_setup():
        B, L, D, N = 1, 2048, 448, 256
        A_re = -(lambda _x: torch.exp(torch.as_tensor(_x)))((lambda *s: torch.randn(*s, dtype=torch.bfloat16) * 3.2)(D, N))
        A_im = torch.pi * (lambda *s: torch.randn(*s, dtype=torch.bfloat16) * 0.05)(D, N)
        B_re = (lambda *s: torch.randn(*s, dtype=torch.bfloat16) * 0.05)(D, N)
        B_im = (lambda *s: torch.randn(*s, dtype=torch.bfloat16) * 0.05)(D, N)
        C_re = (lambda *s: torch.randn(*s, dtype=torch.bfloat16) * 0.05)(D, N)
        C_im = (lambda *s: torch.randn(*s, dtype=torch.bfloat16) * 0.05)(D, N)
        log_dt = (lambda *s: torch.randn(*s, dtype=torch.bfloat16) * 0.05)(D) * 0.5 - 4.0
        Dskip = (lambda *s: torch.randn(*s, dtype=torch.bfloat16) * 0.05)(D)
        return {
            "u": _w((lambda *s: torch.randn(*s, dtype=torch.bfloat16) * 0.05)(B, L, D)),
            "A_re": _w(A_re),
            "A_im": _w(A_im),
            "B_re": _w(B_re),
            "B_im": _w(B_im),
            "C_re": _w(C_re),
            "C_im": _w(C_im),
            "log_dt": _w(log_dt),
            "Dskip": _w(Dskip),
        }
    _A_in = _A_setup()

    def _B_setup():
        B, S, D, F = 1, 2048, 448, 1792
        return {
            "x": _w((lambda *s: torch.randn(*s, dtype=torch.bfloat16) * 0.05)(B, S, D)),
            "w_gate": _w((lambda *s: torch.randn(*s, dtype=torch.bfloat16) * 0.05)(D, F)),
            "w_up": _w((lambda *s: torch.randn(*s, dtype=torch.bfloat16) * 0.05)(D, F)),
            "w_down": _w((lambda *s: torch.randn(*s, dtype=torch.bfloat16) * 0.05)(F, D)),
        }
    _B_in = _B_setup()

    return {
        "A_u": _A_in["u"],
        "A_A_re": _A_in["A_re"],
        "A_A_im": _A_in["A_im"],
        "A_B_re": _A_in["B_re"],
        "A_B_im": _A_in["B_im"],
        "A_C_re": _A_in["C_re"],
        "A_C_im": _A_in["C_im"],
        "A_log_dt": _A_in["log_dt"],
        "A_Dskip": _A_in["Dskip"],
        "B_x": _B_in["x"],
        "B_w_gate": _B_in["w_gate"],
        "B_w_up": _B_in["w_up"],
        "B_w_down": _B_in["w_down"],
    }

def reference(A_u, A_A_re, A_A_im, A_B_re, A_B_im, A_C_re, A_C_im, A_log_dt, A_Dskip, B_x, B_w_gate, B_w_up, B_w_down):
    def _A_ref(u, A_re, A_im, B_re, B_im, C_re, C_im, log_dt, Dskip):
        Bsz, L, D = u.shape
        dt = torch.exp(log_dt)[:, None]
        A = A_re + 1j * A_im
        Bc = B_re + 1j * B_im
        Cc = C_re + 1j * C_im
        logdA = dt * A
        dB = dt * Bc
        l = (lambda x, dt: x.to(dt))(torch.arange(L), A_re.dtype)
        P = torch.exp(logdA[:, :, None] * l[None, None, :])
        K = torch.einsum("dn,dnl,dn->dl", Cc, P, dB).real
        L2 = 2 * L
        Kp = _pad(K, ((0, 0), (0, L)))
        up = (lambda x, *d: x.permute(*d))(u, 0, 2, 1)
        up = _pad(up, ((0, 0), (0, 0), (0, L)))
        Kf = (lambda x, axes=(-2,-1): torch.fft.rfft2(x.float(), dim=axes))(Kp[:, None, :], axes=(-2, -1))
        Uf = (lambda x, axes=(-2,-1): torch.fft.rfft2(x.float(), dim=axes))(up[:, :, None, :], axes=(-2, -1))
        Yf = Uf * Kf[None, :, :, :]
        y = (lambda x, s, axes=(-2,-1): torch.fft.irfft2(x, s=s, dim=axes).to(torch.bfloat16))(Yf, (1, L2), axes=(-2, -1))[:, :, 0, :L]
        y = (lambda x, *d: x.permute(*d))(y, 0, 2, 1) + u * Dskip[None, None, :]
        return y

    def _B_ref(x, w_gate, w_up, w_down):
        g = _silu(x @ w_gate)
        u = x @ w_up
        return (g * u) @ w_down

    x = A_u
    h = x + _A_ref(_layernorm(x, axis=-1), A_A_re, A_A_im, A_B_re, A_B_im, A_C_re, A_C_im, A_log_dt, A_Dskip)
    h2 = h + _B_ref(_layernorm(h, axis=-1), B_w_gate, B_w_up, B_w_down)
    return h2
```

```asm
; @launch grid=(256,1,1) block=(256,1,1) lds=163840
.amdgcn_target "amdgcn-amd-amdhsa--gfx950"
.text
.globl sequential_preLN__ssm_conv_s4__swiglu_ffn__prompt_kernel
.p2align 8
.type sequential_preLN__ssm_conv_s4__swiglu_ffn__prompt_kernel,@function
sequential_preLN__ssm_conv_s4__swiglu_ffn__prompt_kernel:
    s_cmp_ge_u32 s2, 256
    s_cbranch_scc1 L_end
    s_load_dwordx16 s[4:19], s[0:1], 0
    s_load_dwordx16 s[20:35], s[0:1], 64
    s_memrealtime s[82:83]
    v_and_b32 v1, 63, v0
    s_getpc_b64 s[86:87]
Lpc_1:
    s_sub_u32 s86, s86, Lpc_1-sequential_preLN__ssm_conv_s4__swiglu_ffn__prompt_kernel
    s_subb_u32 s87, s87, 0
    s_lshr_b32 s69, s2, 3
    s_lshl_b32 s69, s69, 4
    v_lshrrev_b32 v250, 6, v0
    v_lshl_add_u32 v250, v250, 2, v1
    v_add_u32 v250, s69, v250
    v_lshlrev_b32 v250, 7, v250
    v_min_u32 v250, L_end-sequential_preLN__ssm_conv_s4__swiglu_ffn__prompt_kernel, v250
    v_mov_b32 v253, s87
    v_add_co_u32 v252, vcc, s86, v250
    s_nop 1
    v_addc_co_u32 v253, vcc, 0, v253, vcc
    s_mov_b64 s[84:85], exec
    s_mov_b64 exec, 15
    global_load_dword v251, v[252:253], off
    s_mov_b64 exec, s[84:85]
    v_lshrrev_b32 v2, 6, v0
    s_and_b32 s66, s2, 7
    s_lshr_b32 s67, s2, 3
    v_readfirstlane_b32 s64, v2
    s_cmp_lt_u32 s67, 4
    s_cbranch_scc1 L_helper
    s_sub_u32 s67, s67, 4
    s_mul_i32 s68, s66, 28
    s_add_u32 s68, s68, s67
    s_branch L_worker
L_helper:
    s_waitcnt lgkmcnt(0)
    s_mov_b32 s44, s32
    s_mov_b32 s45, s33
    s_mov_b32 s46, 0x100
    s_mov_b32 s47, 0x20000
    s_or_b32 s65, s82, 1
    s_mov_b32 s98, s82
    s_or_b32 s69, s2, s64
    s_cmp_lg_u32 s69, 0
    s_cbranch_scc1 Lnon_2
    v_mov_b32 v2, s65
    v_mov_b32 v3, 0
    s_mov_b64 s[84:85], exec
    s_mov_b64 exec, 1
    buffer_store_dword v2, v3, s[44:47], 0 offen sc1
    s_mov_b64 exec, s[84:85]
Lnon_2:
    s_mov_b32 s36, s4
    s_mov_b32 s37, s5
    s_mov_b32 s38, 0x1c0000
    s_mov_b32 s39, 0x20000
    s_mov_b32 s98, s82
    s_lshl_b32 s69, s66, 2
    s_add_u32 s91, s67, s69
    s_lshl_b32 s69, s91, 6
    s_lshl_b32 s70, s64, 4
    s_add_u32 s69, s69, s70
    s_mul_i32 s71, s69, 896
    s_mul_i32 s72, s70, 912
    v_lshlrev_b32 v2, 4, v1
    s_mov_b64 s[84:85], exec
    s_mov_b32 exec_lo, -1
    s_mov_b32 exec_hi, 0x00ffffff
    s_add_u32 m0, s72, 0
    s_add_u32 s73, s71, 0
    buffer_load_dwordx4 v2, s[36:39], s73 offen lds
    s_add_u32 m0, s72, 912
    s_add_u32 s73, s71, 896
    buffer_load_dwordx4 v2, s[36:39], s73 offen lds
    s_add_u32 m0, s72, 1824
    s_add_u32 s73, s71, 1792
    buffer_load_dwordx4 v2, s[36:39], s73 offen lds
    s_add_u32 m0, s72, 2736
    s_add_u32 s73, s71, 2688
    buffer_load_dwordx4 v2, s[36:39], s73 offen lds
    s_add_u32 m0, s72, 3648
    s_add_u32 s73, s71, 3584
    buffer_load_dwordx4 v2, s[36:39], s73 offen lds
    s_add_u32 m0, s72, 4560
    s_add_u32 s73, s71, 4480
    buffer_load_dwordx4 v2, s[36:39], s73 offen lds
    s_add_u32 m0, s72, 5472
    s_add_u32 s73, s71, 5376
    buffer_load_dwordx4 v2, s[36:39], s73 offen lds
    s_add_u32 m0, s72, 6384
    s_add_u32 s73, s71, 6272
    buffer_load_dwordx4 v2, s[36:39], s73 offen lds
    s_add_u32 m0, s72, 7296
    s_add_u32 s73, s71, 7168
    buffer_load_dwordx4 v2, s[36:39], s73 offen lds
    s_add_u32 m0, s72, 8208
    s_add_u32 s73, s71, 8064
    buffer_load_dwordx4 v2, s[36:39], s73 offen lds
    s_add_u32 m0, s72, 9120
    s_add_u32 s73, s71, 8960
    buffer_load_dwordx4 v2, s[36:39], s73 offen lds
    s_add_u32 m0, s72, 10032
    s_add_u32 s73, s71, 9856
    buffer_load_dwordx4 v2, s[36:39], s73 offen lds
    s_add_u32 m0, s72, 10944
    s_add_u32 s73, s71, 10752
    buffer_load_dwordx4 v2, s[36:39], s73 offen lds
    s_add_u32 m0, s72, 11856
    s_add_u32 s73, s71, 11648
    buffer_load_dwordx4 v2, s[36:39], s73 offen lds
    s_add_u32 m0, s72, 12768
    s_add_u32 s73, s71, 12544
    buffer_load_dwordx4 v2, s[36:39], s73 offen lds
    s_add_u32 m0, s72, 13680
    s_add_u32 s73, s71, 13440
    buffer_load_dwordx4 v2, s[36:39], s73 offen lds
    s_mov_b64 exec, s[84:85]
    s_mov_b32 s40, s34
    s_mov_b32 s41, s35
    s_mov_b32 s42, 0x2000000
    s_mov_b32 s43, 0x20000
    s_mov_b32 s48, s24
    s_mov_b32 s49, s25
    s_mov_b32 s50, 0x188000
    s_mov_b32 s51, 0x20000
    s_mov_b32 s52, s26
    s_mov_b32 s53, s27
    s_mov_b32 s54, 0x188000
    s_mov_b32 s55, 0x20000
    s_mov_b32 s56, s28
    s_mov_b32 s57, s29
    s_mov_b32 s58, 0x188000
    s_mov_b32 s59, 0x20000
    s_mov_b32 s60, s30
    s_mov_b32 s61, s31
    s_mov_b32 s62, 0x1c0000
    s_mov_b32 s63, 0x20000
    v_lshrrev_b32 v3, 4, v1
    v_lshlrev_b32 v3, 1, v3
    v_bfe_u32 v4, v1, 1, 1
    v_add_u32 v3, v3, v4
    v_lshlrev_b32 v3, 3, v3
    v_bfe_u32 v4, v1, 2, 2
    v_add_u32 v3, v3, v4
    v_mul_u32_u24 v5, 912, v3
    v_and_b32 v4, 1, v1
    v_lshl_add_u32 v5, v4, 3, v5
    s_lshl_b32 s69, s64, 4
    v_add_u32 v5, s69, v5
    s_lshl_b32 s69, s64, 15
    s_lshl_b32 s70, s91, 10
    s_add_u32 s69, s69, s70
    s_add_u32 s69, s69, 11534336
    v_lshl_add_u32 v6, v1, 4, s69
    v_and_b32 v3, 15, v1
    v_lshrrev_b32 v4, 4, v1
    s_lshl_b32 s69, s64, 4
    v_add_u32 v3, s69, v3
    v_mul_u32_u24 v7, 912, v3
    v_lshl_add_u32 v7, v4, 4, v7
    s_lshl_b32 s69, s91, 6
    v_add_u32 v3, s69, v3
    v_mov_b32 v9, 0
    s_mov_b32 s90, 0
Lgn_3:
    buffer_load_dword v8, v9, s[44:47], 0 offen sc1
    s_waitcnt vmcnt(0)
    v_readfirstlane_b32 s65, v8
    s_nop 0
    s_cmp_lg_u32 s65, 0
    s_cbranch_scc1 Lgnd_4
    s_add_u32 s90, s90, 1
    s_cmp_lt_u32 s90, 50000
    s_cbranch_scc1 Lgn_3
Lgnd_4:
    ds_read_b128 v[64:67], v7 offset:0
    ds_read_b128 v[68:71], v7 offset:64
    ds_read_b128 v[72:75], v7 offset:128
    ds_read_b128 v[76:79], v7 offset:192
    ds_read_b128 v[80:83], v7 offset:256
    ds_read_b128 v[84:87], v7 offset:320
    ds_read_b128 v[88:91], v7 offset:384
    ds_read_b128 v[92:95], v7 offset:448
    ds_read_b128 v[96:99], v7 offset:512
    ds_read_b128 v[100:103], v7 offset:576
    ds_read_b128 v[104:107], v7 offset:640
    ds_read_b128 v[108:111], v7 offset:704
    ds_read_b128 v[112:115], v7 offset:768
    ds_read_b128 v[116:119], v7 offset:832
    v_mov_b32 v128, 0x3f803f80
    v_mov_b32 v129, 0x3f803f80
    v_mov_b32 v130, 0x3f803f80
    v_mov_b32 v131, 0x3f803f80
    s_mov_b32 s6, 0x22222222
    s_mov_b32 s7, 0x22222222
    s_mov_b32 s8, 0x44444444
    s_mov_b32 s9, 0x44444444
    s_mov_b32 s10, 0x88888888
    s_mov_b32 s11, 0x88888888
    s_mov_b32 s12, 0x00f0000f
    s_mov_b32 s13, 0xf0000f00
    s_waitcnt lgkmcnt(13)
    v_mfma_f32_16x16x32_bf16 v[120:123], v[64:67], v[64:67], 0
    v_mfma_f32_16x16x32_bf16 v[124:127], v[128:131], v[64:67], 0
    s_waitcnt lgkmcnt(12)
    v_mfma_f32_16x16x32_bf16 v[120:123], v[68:71], v[68:71], v[120:123]
    v_mfma_f32_16x16x32_bf16 v[124:127], v[128:131], v[68:71], v[124:127]
    s_waitcnt lgkmcnt(11)
    v_mfma_f32_16x16x32_bf16 v[120:123], v[72:75], v[72:75], v[120:123]
    v_mfma_f32_16x16x32_bf16 v[124:127], v[128:131], v[72:75], v[124:127]
    s_waitcnt lgkmcnt(10)
    v_mfma_f32_16x16x32_bf16 v[120:123], v[76:79], v[76:79], v[120:123]
    v_mfma_f32_16x16x32_bf16 v[124:127], v[128:131], v[76:79], v[124:127]
    s_waitcnt lgkmcnt(9)
    v_mfma_f32_16x16x32_bf16 v[120:123], v[80:83], v[80:83], v[120:123]
    v_mfma_f32_16x16x32_bf16 v[124:127], v[128:131], v[80:83], v[124:127]
    s_waitcnt lgkmcnt(8)
    v_mfma_f32_16x16x32_bf16 v[120:123], v[84:87], v[84:87], v[120:123]
    v_mfma_f32_16x16x32_bf16 v[124:127], v[128:131], v[84:87], v[124:127]
    s_waitcnt lgkmcnt(7)
    v_mfma_f32_16x16x32_bf16 v[120:123], v[88:91], v[88:91], v[120:123]
    v_mfma_f32_16x16x32_bf16 v[124:127], v[128:131], v[88:91], v[124:127]
    s_waitcnt lgkmcnt(6)
    v_mfma_f32_16x16x32_bf16 v[120:123], v[92:95], v[92:95], v[120:123]
    v_mfma_f32_16x16x32_bf16 v[124:127], v[128:131], v[92:95], v[124:127]
    s_waitcnt lgkmcnt(5)
    v_mfma_f32_16x16x32_bf16 v[120:123], v[96:99], v[96:99], v[120:123]
    v_mfma_f32_16x16x32_bf16 v[124:127], v[128:131], v[96:99], v[124:127]
    s_waitcnt lgkmcnt(4)
    v_mfma_f32_16x16x32_bf16 v[120:123], v[100:103], v[100:103], v[120:123]
    v_mfma_f32_16x16x32_bf16 v[124:127], v[128:131], v[100:103], v[124:127]
    s_waitcnt lgkmcnt(3)
    v_mfma_f32_16x16x32_bf16 v[120:123], v[104:107], v[104:107], v[120:123]
    v_mfma_f32_16x16x32_bf16 v[124:127], v[128:131], v[104:107], v[124:127]
    s_waitcnt lgkmcnt(2)
    v_mfma_f32_16x16x32_bf16 v[120:123], v[108:111], v[108:111], v[120:123]
    v_mfma_f32_16x16x32_bf16 v[124:127], v[128:131], v[108:111], v[124:127]
    s_waitcnt lgkmcnt(1)
    v_mfma_f32_16x16x32_bf16 v[120:123], v[112:115], v[112:115], v[120:123]
    v_mfma_f32_16x16x32_bf16 v[124:127], v[128:131], v[112:115], v[124:127]
    s_waitcnt lgkmcnt(0)
    v_mfma_f32_16x16x32_bf16 v[120:123], v[116:119], v[116:119], v[120:123]
    v_mfma_f32_16x16x32_bf16 v[124:127], v[128:131], v[116:119], v[124:127]
    s_nop 6
    v_cndmask_b32 v120, v120, v121, s[6:7]
    v_cndmask_b32 v120, v120, v122, s[8:9]
    v_cndmask_b32 v125, v120, v123, s[10:11]
    v_mov_b32 v120, v124
    v_mov_b32 v124, v125
    v_mul_f32 v120, 0x3b124925, v120
    v_mul_f32 v124, 0x3b124925, v124
    v_fma_f32 v124, -v120, v120, v124
    v_max_f32 v124, 0, v124
    v_cvt_pk_bf16_f32 v121, v120, v120
    v_lshlrev_b32 v121, 16, v121
    v_cvt_pk_bf16_f32 v123, v124, v124
    v_lshlrev_b32 v123, 16, v123
    v_add_f32 v123, 0x3727c5ac, v123
    v_cvt_pk_bf16_f32 v123, v123, v123
    v_lshlrev_b32 v123, 16, v123
    v_sqrt_f32 v123, v123
    s_nop 0
    v_cvt_pk_bf16_f32 v122, v123, v123
    v_lshlrev_b32 v122, 16, v122
    v_lshrrev_b32 v132, 16, v121
    v_or_b32 v132, v132, v122
    v_mov_b32 v133, s65
    v_lshlrev_b32 v3, 3, v3
    s_mov_b64 s[84:85], exec
    s_mov_b64 exec, s[12:13]
    buffer_store_dwordx2 v[132:133], v3, s[40:43], 0 offen sc1
    s_mov_b64 exec, s[84:85]
    s_barrier
    v_lshrrev_b32 v3, 4, v0
    v_and_b32 v4, 15, v0
    v_mul_u32_u24 v2, 3584, v3
    v_min_u32 v4, 13, v4
    v_lshl_add_u32 v2, v4, 4, v2
    s_and_b32 s69, s91, 15
    s_mul_i32 s69, s69, 224
    v_add_u32 v2, s69, v2
    s_cmp_ge_u32 s91, 16
    s_cbranch_scc1 Lhg_5
    s_mov_b32 s70, 0
    buffer_load_dwordx4 v[8:11], v2, s[48:51], s70 offen
    s_mov_b32 s70, 57344
    buffer_load_dwordx4 v[12:15], v2, s[48:51], s70 offen
    s_mov_b32 s70, 114688
    buffer_load_dwordx4 v[16:19], v2, s[48:51], s70 offen
    s_mov_b32 s70, 172032
    buffer_load_dwordx4 v[20:23], v2, s[48:51], s70 offen
    s_mov_b32 s70, 229376
    buffer_load_dwordx4 v[24:27], v2, s[48:51], s70 offen
    s_mov_b32 s70, 286720
    buffer_load_dwordx4 v[28:31], v2, s[48:51], s70 offen
    s_mov_b32 s70, 344064
    buffer_load_dwordx4 v[32:35], v2, s[48:51], s70 offen
    s_mov_b32 s70, 401408
    buffer_load_dwordx4 v[36:39], v2, s[48:51], s70 offen
    s_mov_b32 s70, 458752
    buffer_load_dwordx4 v[40:43], v2, s[48:51], s70 offen
    s_mov_b32 s70, 516096
    buffer_load_dwordx4 v[44:47], v2, s[48:51], s70 offen
    s_mov_b32 s70, 573440
    buffer_load_dwordx4 v[48:51], v2, s[48:51], s70 offen
    s_mov_b32 s70, 630784
    buffer_load_dwordx4 v[52:55], v2, s[48:51], s70 offen
    s_mov_b32 s70, 688128
    buffer_load_dwordx4 v[56:59], v2, s[48:51], s70 offen
    s_mov_b32 s70, 745472
    buffer_load_dwordx4 v[60:63], v2, s[48:51], s70 offen
    s_mov_b32 s70, 802816
    buffer_load_dwordx4 v[64:67], v2, s[48:51], s70 offen
    s_mov_b32 s70, 860160
    buffer_load_dwordx4 v[68:71], v2, s[48:51], s70 offen
    s_mov_b32 s70, 917504
    buffer_load_dwordx4 v[72:75], v2, s[48:51], s70 offen
    s_mov_b32 s70, 974848
    buffer_load_dwordx4 v[76:79], v2, s[48:51], s70 offen
    s_mov_b32 s70, 1032192
    buffer_load_dwordx4 v[80:83], v2, s[48:51], s70 offen
    s_mov_b32 s70, 1089536
    buffer_load_dwordx4 v[84:87], v2, s[48:51], s70 offen
    s_mov_b32 s70, 1146880
    buffer_load_dwordx4 v[88:91], v2, s[48:51], s70 offen
    s_mov_b32 s70, 1204224
    buffer_load_dwordx4 v[92:95], v2, s[48:51], s70 offen
    s_mov_b32 s70, 1261568
    buffer_load_dwordx4 v[96:99], v2, s[48:51], s70 offen
    s_mov_b32 s70, 1318912
    buffer_load_dwordx4 v[100:103], v2, s[48:51], s70 offen
    s_mov_b32 s70, 1376256
    buffer_load_dwordx4 v[104:107], v2, s[48:51], s70 offen
    s_mov_b32 s70, 1433600
    buffer_load_dwordx4 v[108:111], v2, s[48:51], s70 offen
    s_mov_b32 s70, 1490944
    buffer_load_dwordx4 v[112:115], v2, s[48:51], s70 offen
    s_mov_b32 s70, 1548288
    buffer_load_dwordx4 v[116:119], v2, s[48:51], s70 offen
    s_branch Lhd_6
Lhg_5:
    s_mov_b32 s70, 0
    buffer_load_dwordx4 v[8:11], v2, s[52:55], s70 offen
    s_mov_b32 s70, 57344
    buffer_load_dwordx4 v[12:15], v2, s[52:55], s70 offen
    s_mov_b32 s70, 114688
    buffer_load_dwordx4 v[16:19], v2, s[52:55], s70 offen
    s_mov_b32 s70, 172032
    buffer_load_dwordx4 v[20:23], v2, s[52:55], s70 offen
    s_mov_b32 s70, 229376
    buffer_load_dwordx4 v[24:27], v2, s[52:55], s70 offen
    s_mov_b32 s70, 286720
    buffer_load_dwordx4 v[28:31], v2, s[52:55], s70 offen
    s_mov_b32 s70, 344064
    buffer_load_dwordx4 v[32:35], v2, s[52:55], s70 offen
    s_mov_b32 s70, 401408
    buffer_load_dwordx4 v[36:39], v2, s[52:55], s70 offen
    s_mov_b32 s70, 458752
    buffer_load_dwordx4 v[40:43], v2, s[52:55], s70 offen
    s_mov_b32 s70, 516096
    buffer_load_dwordx4 v[44:47], v2, s[52:55], s70 offen
    s_mov_b32 s70, 573440
    buffer_load_dwordx4 v[48:51], v2, s[52:55], s70 offen
    s_mov_b32 s70, 630784
    buffer_load_dwordx4 v[52:55], v2, s[52:55], s70 offen
    s_mov_b32 s70, 688128
    buffer_load_dwordx4 v[56:59], v2, s[52:55], s70 offen
    s_mov_b32 s70, 745472
    buffer_load_dwordx4 v[60:63], v2, s[52:55], s70 offen
    s_mov_b32 s70, 802816
    buffer_load_dwordx4 v[64:67], v2, s[52:55], s70 offen
    s_mov_b32 s70, 860160
    buffer_load_dwordx4 v[68:71], v2, s[52:55], s70 offen
    s_mov_b32 s70, 917504
    buffer_load_dwordx4 v[72:75], v2, s[52:55], s70 offen
    s_mov_b32 s70, 974848
    buffer_load_dwordx4 v[76:79], v2, s[52:55], s70 offen
    s_mov_b32 s70, 1032192
    buffer_load_dwordx4 v[80:83], v2, s[52:55], s70 offen
    s_mov_b32 s70, 1089536
    buffer_load_dwordx4 v[84:87], v2, s[52:55], s70 offen
    s_mov_b32 s70, 1146880
    buffer_load_dwordx4 v[88:91], v2, s[52:55], s70 offen
    s_mov_b32 s70, 1204224
    buffer_load_dwordx4 v[92:95], v2, s[52:55], s70 offen
    s_mov_b32 s70, 1261568
    buffer_load_dwordx4 v[96:99], v2, s[52:55], s70 offen
    s_mov_b32 s70, 1318912
    buffer_load_dwordx4 v[100:103], v2, s[52:55], s70 offen
    s_mov_b32 s70, 1376256
    buffer_load_dwordx4 v[104:107], v2, s[52:55], s70 offen
    s_mov_b32 s70, 1433600
    buffer_load_dwordx4 v[108:111], v2, s[52:55], s70 offen
    s_mov_b32 s70, 1490944
    buffer_load_dwordx4 v[112:115], v2, s[52:55], s70 offen
    s_mov_b32 s70, 1548288
    buffer_load_dwordx4 v[116:119], v2, s[52:55], s70 offen
Lhd_6:
    s_mov_b32 s71, 0x00003f80
    s_mov_b32 s72, 0x3f800000
    v_mov_b32 v120, 0
    v_mov_b32 v121, 0
    v_mov_b32 v122, 0
    v_mov_b32 v123, 0
    v_mov_b32 v124, 0
    v_mov_b32 v125, 0
    v_mov_b32 v126, 0
    v_mov_b32 v127, 0
    s_waitcnt vmcnt(27)
    v_dot2_f32_bf16 v120, v8, s71, v120
    v_dot2_f32_bf16 v121, v8, s72, v121
    v_dot2_f32_bf16 v122, v9, s71, v122
    v_dot2_f32_bf16 v123, v9, s72, v123
    v_dot2_f32_bf16 v124, v10, s71, v124
    v_dot2_f32_bf16 v125, v10, s72, v125
    v_dot2_f32_bf16 v126, v11, s71, v126
    v_dot2_f32_bf16 v127, v11, s72, v127
    s_waitcnt vmcnt(26)
    v_dot2_f32_bf16 v120, v12, s71, v120
    v_dot2_f32_bf16 v121, v12, s72, v121
    v_dot2_f32_bf16 v122, v13, s71, v122
    v_dot2_f32_bf16 v123, v13, s72, v123
    v_dot2_f32_bf16 v124, v14, s71, v124
    v_dot2_f32_bf16 v125, v14, s72, v125
    v_dot2_f32_bf16 v126, v15, s71, v126
    v_dot2_f32_bf16 v127, v15, s72, v127
    s_waitcnt vmcnt(25)
    v_dot2_f32_bf16 v120, v16, s71, v120
    v_dot2_f32_bf16 v121, v16, s72, v121
    v_dot2_f32_bf16 v122, v17, s71, v122
    v_dot2_f32_bf16 v123, v17, s72, v123
    v_dot2_f32_bf16 v124, v18, s71, v124
    v_dot2_f32_bf16 v125, v18, s72, v125
    v_dot2_f32_bf16 v126, v19, s71, v126
    v_dot2_f32_bf16 v127, v19, s72, v127
    s_waitcnt vmcnt(24)
    v_dot2_f32_bf16 v120, v20, s71, v120
    v_dot2_f32_bf16 v121, v20, s72, v121
    v_dot2_f32_bf16 v122, v21, s71, v122
    v_dot2_f32_bf16 v123, v21, s72, v123
    v_dot2_f32_bf16 v124, v22, s71, v124
    v_dot2_f32_bf16 v125, v22, s72, v125
    v_dot2_f32_bf16 v126, v23, s71, v126
    v_dot2_f32_bf16 v127, v23, s72, v127
    s_waitcnt vmcnt(23)
    v_dot2_f32_bf16 v120, v24, s71, v120
    v_dot2_f32_bf16 v121, v24, s72, v121
    v_dot2_f32_bf16 v122, v25, s71, v122
    v_dot2_f32_bf16 v123, v25, s72, v123
    v_dot2_f32_bf16 v124, v26, s71, v124
    v_dot2_f32_bf16 v125, v26, s72, v125
    v_dot2_f32_bf16 v126, v27, s71, v126
    v_dot2_f32_bf16 v127, v27, s72, v127
    s_waitcnt vmcnt(22)
    v_dot2_f32_bf16 v120, v28, s71, v120
    v_dot2_f32_bf16 v121, v28, s72, v121
    v_dot2_f32_bf16 v122, v29, s71, v122
    v_dot2_f32_bf16 v123, v29, s72, v123
    v_dot2_f32_bf16 v124, v30, s71, v124
    v_dot2_f32_bf16 v125, v30, s72, v125
    v_dot2_f32_bf16 v126, v31, s71, v126
    v_dot2_f32_bf16 v127, v31, s72, v127
    s_waitcnt vmcnt(21)
    v_dot2_f32_bf16 v120, v32, s71, v120
    v_dot2_f32_bf16 v121, v32, s72, v121
    v_dot2_f32_bf16 v122, v33, s71, v122
    v_dot2_f32_bf16 v123, v33, s72, v123
    v_dot2_f32_bf16 v124, v34, s71, v124
    v_dot2_f32_bf16 v125, v34, s72, v125
    v_dot2_f32_bf16 v126, v35, s71, v126
    v_dot2_f32_bf16 v127, v35, s72, v127
    s_waitcnt vmcnt(20)
    v_dot2_f32_bf16 v120, v36, s71, v120
    v_dot2_f32_bf16 v121, v36, s72, v121
    v_dot2_f32_bf16 v122, v37, s71, v122
    v_dot2_f32_bf16 v123, v37, s72, v123
    v_dot2_f32_bf16 v124, v38, s71, v124
    v_dot2_f32_bf16 v125, v38, s72, v125
    v_dot2_f32_bf16 v126, v39, s71, v126
    v_dot2_f32_bf16 v127, v39, s72, v127
    s_waitcnt vmcnt(19)
    v_dot2_f32_bf16 v120, v40, s71, v120
    v_dot2_f32_bf16 v121, v40, s72, v121
    v_dot2_f32_bf16 v122, v41, s71, v122
    v_dot2_f32_bf16 v123, v41, s72, v123
    v_dot2_f32_bf16 v124, v42, s71, v124
    v_dot2_f32_bf16 v125, v42, s72, v125
    v_dot2_f32_bf16 v126, v43, s71, v126
    v_dot2_f32_bf16 v127, v43, s72, v127
    s_waitcnt vmcnt(18)
    v_dot2_f32_bf16 v120, v44, s71, v120
    v_dot2_f32_bf16 v121, v44, s72, v121
    v_dot2_f32_bf16 v122, v45, s71, v122
    v_dot2_f32_bf16 v123, v45, s72, v123
    v_dot2_f32_bf16 v124, v46, s71, v124
    v_dot2_f32_bf16 v125, v46, s72, v125
    v_dot2_f32_bf16 v126, v47, s71, v126
    v_dot2_f32_bf16 v127, v47, s72, v127
    s_waitcnt vmcnt(17)
    v_dot2_f32_bf16 v120, v48, s71, v120
    v_dot2_f32_bf16 v121, v48, s72, v121
    v_dot2_f32_bf16 v122, v49, s71, v122
    v_dot2_f32_bf16 v123, v49, s72, v123
    v_dot2_f32_bf16 v124, v50, s71, v124
    v_dot2_f32_bf16 v125, v50, s72, v125
    v_dot2_f32_bf16 v126, v51, s71, v126
    v_dot2_f32_bf16 v127, v51, s72, v127
    s_waitcnt vmcnt(16)
    v_dot2_f32_bf16 v120, v52, s71, v120
    v_dot2_f32_bf16 v121, v52, s72, v121
    v_dot2_f32_bf16 v122, v53, s71, v122
    v_dot2_f32_bf16 v123, v53, s72, v123
    v_dot2_f32_bf16 v124, v54, s71, v124
    v_dot2_f32_bf16 v125, v54, s72, v125
    v_dot2_f32_bf16 v126, v55, s71, v126
    v_dot2_f32_bf16 v127, v55, s72, v127
    s_waitcnt vmcnt(15)
    v_dot2_f32_bf16 v120, v56, s71, v120
    v_dot2_f32_bf16 v121, v56, s72, v121
    v_dot2_f32_bf16 v122, v57, s71, v122
    v_dot2_f32_bf16 v123, v57, s72, v123
    v_dot2_f32_bf16 v124, v58, s71, v124
    v_dot2_f32_bf16 v125, v58, s72, v125
    v_dot2_f32_bf16 v126, v59, s71, v126
    v_dot2_f32_bf16 v127, v59, s72, v127
    s_waitcnt vmcnt(14)
    v_dot2_f32_bf16 v120, v60, s71, v120
    v_dot2_f32_bf16 v121, v60, s72, v121
    v_dot2_f32_bf16 v122, v61, s71, v122
    v_dot2_f32_bf16 v123, v61, s72, v123
    v_dot2_f32_bf16 v124, v62, s71, v124
    v_dot2_f32_bf16 v125, v62, s72, v125
    v_dot2_f32_bf16 v126, v63, s71, v126
    v_dot2_f32_bf16 v127, v63, s72, v127
    s_waitcnt vmcnt(13)
    v_dot2_f32_bf16 v120, v64, s71, v120
    v_dot2_f32_bf16 v121, v64, s72, v121
    v_dot2_f32_bf16 v122, v65, s71, v122
    v_dot2_f32_bf16 v123, v65, s72, v123
    v_dot2_f32_bf16 v124, v66, s71, v124
    v_dot2_f32_bf16 v125, v66, s72, v125
    v_dot2_f32_bf16 v126, v67, s71, v126
    v_dot2_f32_bf16 v127, v67, s72, v127
    s_waitcnt vmcnt(12)
    v_dot2_f32_bf16 v120, v68, s71, v120
    v_dot2_f32_bf16 v121, v68, s72, v121
    v_dot2_f32_bf16 v122, v69, s71, v122
    v_dot2_f32_bf16 v123, v69, s72, v123
    v_dot2_f32_bf16 v124, v70, s71, v124
    v_dot2_f32_bf16 v125, v70, s72, v125
    v_dot2_f32_bf16 v126, v71, s71, v126
    v_dot2_f32_bf16 v127, v71, s72, v127
    s_waitcnt vmcnt(11)
    v_dot2_f32_bf16 v120, v72, s71, v120
    v_dot2_f32_bf16 v121, v72, s72, v121
    v_dot2_f32_bf16 v122, v73, s71, v122
    v_dot2_f32_bf16 v123, v73, s72, v123
    v_dot2_f32_bf16 v124, v74, s71, v124
    v_dot2_f32_bf16 v125, v74, s72, v125
    v_dot2_f32_bf16 v126, v75, s71, v126
    v_dot2_f32_bf16 v127, v75, s72, v127
    s_waitcnt vmcnt(10)
    v_dot2_f32_bf16 v120, v76, s71, v120
    v_dot2_f32_bf16 v121, v76, s72, v121
    v_dot2_f32_bf16 v122, v77, s71, v122
    v_dot2_f32_bf16 v123, v77, s72, v123
    v_dot2_f32_bf16 v124, v78, s71, v124
    v_dot2_f32_bf16 v125, v78, s72, v125
    v_dot2_f32_bf16 v126, v79, s71, v126
    v_dot2_f32_bf16 v127, v79, s72, v127
    s_waitcnt vmcnt(9)
    v_dot2_f32_bf16 v120, v80, s71, v120
    v_dot2_f32_bf16 v121, v80, s72, v121
    v_dot2_f32_bf16 v122, v81, s71, v122
    v_dot2_f32_bf16 v123, v81, s72, v123
    v_dot2_f32_bf16 v124, v82, s71, v124
    v_dot2_f32_bf16 v125, v82, s72, v125
    v_dot2_f32_bf16 v126, v83, s71, v126
    v_dot2_f32_bf16 v127, v83, s72, v127
    s_waitcnt vmcnt(8)
    v_dot2_f32_bf16 v120, v84, s71, v120
    v_dot2_f32_bf16 v121, v84, s72, v121
    v_dot2_f32_bf16 v122, v85, s71, v122
    v_dot2_f32_bf16 v123, v85, s72, v123
    v_dot2_f32_bf16 v124, v86, s71, v124
    v_dot2_f32_bf16 v125, v86, s72, v125
    v_dot2_f32_bf16 v126, v87, s71, v126
    v_dot2_f32_bf16 v127, v87, s72, v127
    s_waitcnt vmcnt(7)
    v_dot2_f32_bf16 v120, v88, s71, v120
    v_dot2_f32_bf16 v121, v88, s72, v121
    v_dot2_f32_bf16 v122, v89, s71, v122
    v_dot2_f32_bf16 v123, v89, s72, v123
    v_dot2_f32_bf16 v124, v90, s71, v124
    v_dot2_f32_bf16 v125, v90, s72, v125
    v_dot2_f32_bf16 v126, v91, s71, v126
    v_dot2_f32_bf16 v127, v91, s72, v127
    s_waitcnt vmcnt(6)
    v_dot2_f32_bf16 v120, v92, s71, v120
    v_dot2_f32_bf16 v121, v92, s72, v121
    v_dot2_f32_bf16 v122, v93, s71, v122
    v_dot2_f32_bf16 v123, v93, s72, v123
    v_dot2_f32_bf16 v124, v94, s71, v124
    v_dot2_f32_bf16 v125, v94, s72, v125
    v_dot2_f32_bf16 v126, v95, s71, v126
    v_dot2_f32_bf16 v127, v95, s72, v127
    s_waitcnt vmcnt(5)
    v_dot2_f32_bf16 v120, v96, s71, v120
    v_dot2_f32_bf16 v121, v96, s72, v121
    v_dot2_f32_bf16 v122, v97, s71, v122
    v_dot2_f32_bf16 v123, v97, s72, v123
    v_dot2_f32_bf16 v124, v98, s71, v124
    v_dot2_f32_bf16 v125, v98, s72, v125
    v_dot2_f32_bf16 v126, v99, s71, v126
    v_dot2_f32_bf16 v127, v99, s72, v127
    s_waitcnt vmcnt(4)
    v_dot2_f32_bf16 v120, v100, s71, v120
    v_dot2_f32_bf16 v121, v100, s72, v121
    v_dot2_f32_bf16 v122, v101, s71, v122
    v_dot2_f32_bf16 v123, v101, s72, v123
    v_dot2_f32_bf16 v124, v102, s71, v124
    v_dot2_f32_bf16 v125, v102, s72, v125
    v_dot2_f32_bf16 v126, v103, s71, v126
    v_dot2_f32_bf16 v127, v103, s72, v127
    s_waitcnt vmcnt(3)
    v_dot2_f32_bf16 v120, v104, s71, v120
    v_dot2_f32_bf16 v121, v104, s72, v121
    v_dot2_f32_bf16 v122, v105, s71, v122
    v_dot2_f32_bf16 v123, v105, s72, v123
    v_dot2_f32_bf16 v124, v106, s71, v124
    v_dot2_f32_bf16 v125, v106, s72, v125
    v_dot2_f32_bf16 v126, v107, s71, v126
    v_dot2_f32_bf16 v127, v107, s72, v127
    s_waitcnt vmcnt(2)
    v_dot2_f32_bf16 v120, v108, s71, v120
    v_dot2_f32_bf16 v121, v108, s72, v121
    v_dot2_f32_bf16 v122, v109, s71, v122
    v_dot2_f32_bf16 v123, v109, s72, v123
    v_dot2_f32_bf16 v124, v110, s71, v124
    v_dot2_f32_bf16 v125, v110, s72, v125
    v_dot2_f32_bf16 v126, v111, s71, v126
    v_dot2_f32_bf16 v127, v111, s72, v127
    s_waitcnt vmcnt(1)
    v_dot2_f32_bf16 v120, v112, s71, v120
    v_dot2_f32_bf16 v121, v112, s72, v121
    v_dot2_f32_bf16 v122, v113, s71, v122
    v_dot2_f32_bf16 v123, v113, s72, v123
    v_dot2_f32_bf16 v124, v114, s71, v124
    v_dot2_f32_bf16 v125, v114, s72, v125
    v_dot2_f32_bf16 v126, v115, s71, v126
    v_dot2_f32_bf16 v127, v115, s72, v127
    s_waitcnt vmcnt(0)
    v_dot2_f32_bf16 v120, v116, s71, v120
    v_dot2_f32_bf16 v121, v116, s72, v121
    v_dot2_f32_bf16 v122, v117, s71, v122
    v_dot2_f32_bf16 v123, v117, s72, v123
    v_dot2_f32_bf16 v124, v118, s71, v124
    v_dot2_f32_bf16 v125, v118, s72, v125
    v_dot2_f32_bf16 v126, v119, s71, v126
    v_dot2_f32_bf16 v127, v119, s72, v127
    v_mov_b32 v128, v120
    v_mov_b32 v129, v121
    v_mov_b32 v130, v122
    v_mov_b32 v131, v123
    v_mov_b32 v132, v124
    v_mov_b32 v133, v125
    v_mov_b32 v134, v126
    v_mov_b32 v135, v127
    v_permlane32_swap_b32 v120, v128
    v_permlane32_swap_b32 v121, v129
    v_permlane32_swap_b32 v122, v130
    v_permlane32_swap_b32 v123, v131
    v_permlane32_swap_b32 v124, v132
    v_permlane32_swap_b32 v125, v133
    v_permlane32_swap_b32 v126, v134
    v_permlane32_swap_b32 v127, v135
    v_add_f32 v120, v120, v128
    v_add_f32 v121, v121, v129
    v_add_f32 v122, v122, v130
    v_add_f32 v123, v123, v131
    v_add_f32 v124, v124, v132
    v_add_f32 v125, v125, v133
    v_add_f32 v126, v126, v134
    v_add_f32 v127, v127, v135
    v_mov_b32 v128, v120
    v_mov_b32 v129, v121
    v_mov_b32 v130, v122
    v_mov_b32 v131, v123
    v_mov_b32 v132, v124
    v_mov_b32 v133, v125
    v_mov_b32 v134, v126
    v_mov_b32 v135, v127
    v_permlane16_swap_b32 v120, v128
    v_permlane16_swap_b32 v121, v129
    v_permlane16_swap_b32 v122, v130
    v_permlane16_swap_b32 v123, v131
    v_permlane16_swap_b32 v124, v132
    v_permlane16_swap_b32 v125, v133
    v_permlane16_swap_b32 v126, v134
    v_permlane16_swap_b32 v127, v135
    v_add_f32 v120, v120, v128
    v_add_f32 v121, v121, v129
    v_add_f32 v122, v122, v130
    v_add_f32 v123, v123, v131
    v_add_f32 v124, v124, v132
    v_add_f32 v125, v125, v133
    v_add_f32 v126, v126, v134
    v_add_f32 v127, v127, v135
    v_and_b32 v4, 15, v1
    v_lshlrev_b32 v3, 5, v4
    s_lshl_b32 s69, s64, 9
    v_add_u32 v3, s69, v3
    ds_write_b128 v3, v[120:123]
    ds_write_b128 v3, v[124:127] offset:16
    s_waitcnt lgkmcnt(0)
    s_barrier
    v_lshlrev_b32 v3, 2, v0
    ds_read_b32 v128, v3 offset:0
    ds_read_b32 v129, v3 offset:512
    ds_read_b32 v130, v3 offset:1024
    ds_read_b32 v131, v3 offset:1536
    s_waitcnt lgkmcnt(0)
    v_add_f32 v128, v128, v129
    v_add_f32 v130, v130, v131
    v_add_f32 v128, v128, v130
    s_mul_i32 s69, s91, 448
    s_add_u32 s69, s69, 81920
    v_add_u32 v3, s69, v3
    v_cmp_gt_u32 vcc, 112, v0
    s_nop 0
    s_and_saveexec_b64 s[84:85], vcc
    s_cbranch_execz Lhcs_7
    buffer_store_dword v128, v3, s[40:43], 0 offen sc1
Lhcs_7:
    s_mov_b64 exec, s[84:85]
    s_waitcnt vmcnt(0)
    s_barrier
    s_cmp_lg_u32 s64, 0
    s_cbranch_scc1 Lsig_8
    s_mul_i32 s69, s2, 16
    s_add_u32 s69, s69, 16384
    v_mov_b32 v6, s65
    v_mov_b32 v7, s69
    s_mov_b64 s[84:85], exec
    s_mov_b64 exec, 1
    buffer_store_dword v6, v7, s[40:43], 0 offen sc1
    s_mov_b64 exec, s[84:85]
Lsig_8:
    s_mul_i32 s69, s91, 50176
    v_add_u32 v20, 0, v0
    v_min_u32 v20, 391, v20
    v_mul_u32_u24 v21, 9363, v20
    v_lshrrev_b32 v21, 16, v21
    v_mul_u32_u24 v6, 7, v21
    v_sub_u32 v20, v20, v6
    v_mul_u32_u24 v21, 896, v21
    v_lshl_add_u32 v21, v20, 7, v21
    buffer_load_dword v6, v21, s[56:59], s69 offen
    v_add_u32 v20, 256, v0
    v_min_u32 v20, 391, v20
    v_mul_u32_u24 v21, 9363, v20
    v_lshrrev_b32 v21, 16, v21
    v_mul_u32_u24 v7, 7, v21
    v_sub_u32 v20, v20, v7
    v_mul_u32_u24 v21, 896, v21
    v_lshl_add_u32 v21, v20, 7, v21
    buffer_load_dword v7, v21, s[56:59], s69 offen
    s_waitcnt vmcnt(0)
    v_lshrrev_b32 v3, 3, v1
    v_mul_u32_u24 v5, 4352, v3
    v_bfe_u32 v3, v1, 4, 1
    v_lshlrev_b32 v3, 2, v3
    v_and_b32 v4, 7, v1
    v_xor_b32 v3, v3, v4
    v_lshl_add_u32 v5, v3, 4, v5
    s_lshl_b32 s69, s91, 7
    s_mul_i32 s70, s64, 34816
    s_add_u32 s69, s69, s70
    s_add_u32 s69, s69, 131072
    v_add_u32 v5, s69, v5
    v_lshrrev_b32 v3, 5, v1
    v_lshlrev_b32 v6, 9, v3
    v_bfe_u32 v3, v1, 2, 2
    v_lshl_add_u32 v6, v3, 7, v6
    v_bfe_u32 v3, v1, 4, 1
    v_lshl_add_u32 v6, v3, 5, v6
    v_and_b32 v3, 3, v1
    v_lshl_add_u32 v6, v3, 3, v6
    v_bfe_u32 v3, v1, 3, 1
    v_lshlrev_b32 v3, 6, v3
    v_xor_b32 v4, 64, v3
    v_add_u32 v7, v6, v4
    v_add_u32 v6, v6, v3
    v_lshrrev_b32 v3, 4, v1
    v_lshlrev_b32 v8, 9, v3
    v_bfe_u32 v3, v1, 2, 2
    v_lshl_add_u32 v8, v3, 7, v8
    v_and_b32 v3, 3, v1
    v_lshl_add_u32 v8, v3, 3, v8
    v_bfe_u32 v3, v1, 3, 1
    s_lshr_b32 s69, s64, 1
    v_xor_b32 v3, s69, v3
    v_lshl_add_u32 v8, v3, 6, v8
    s_and_b32 s69, s64, 1
    s_lshl_b32 s69, s69, 5
    v_add_u32 v8, s69, v8
    s_mul_i32 s69, s91, 56
    s_add_u32 s69, s69, s64
    s_lshl_b32 s69, s69, 10
    s_add_u32 s69, s69, 2097152
    v_lshl_add_u32 v9, v1, 4, s69
    v_mov_b32 v12, 0x3f803f80
    v_mov_b32 v13, 0x3f803f80
    v_mov_b32 v14, 0x3f803f80
    v_mov_b32 v15, 0x3f803f80
    s_mov_b32 s6, 0x22222222
    s_mov_b32 s7, 0x22222222
    s_mov_b32 s8, 0x44444444
    s_mov_b32 s9, 0x44444444
    s_mov_b32 s10, 0x88888888
    s_mov_b32 s11, 0x88888888
    s_mov_b32 s12, 0x00f0000f
    s_mov_b32 s13, 0xf0000f00
    s_cmp_lg_u32 s64, 0
    s_cbranch_scc1 Lpf_9
    v_mul_u32_u24 v10, 16, v1
    v_add_u32 v10, 20464, v10
    s_mov_b64 s[84:85], exec
    s_mov_b64 exec, 0x1
    s_mov_b32 s90, 0
Lpl_10:
    buffer_load_dword v80, v10, s[40:43], 0 offen offset:0 sc1
    s_waitcnt vmcnt(0)
    v_cmp_ne_u32 vcc, s65, v80
    s_cbranch_vccz Lpd_11
    s_sleep 20
    s_add_u32 s90, s90, 1
    s_cmp_lt_u32 s90, 50000
    s_cbranch_scc1 Lpl_10
Lpd_11:
    s_mov_b64 exec, s[84:85]
Lpf_9:
    s_barrier
    s_cmp_lg_u32 s64, 0
    s_cbranch_scc1 Lpf_12
    v_mul_u32_u24 v10, 16, v1
    v_add_u32 v10, 16896, v10
    s_mov_b64 s[84:85], exec
    s_mov_b32 s90, 0
Lpl_13:
    buffer_load_dword v80, v10, s[40:43], 0 offen offset:0 sc1
    buffer_load_dword v81, v10, s[40:43], 0 offen offset:1024 sc1
    buffer_load_dword v82, v10, s[40:43], 0 offen offset:2048 sc1
    buffer_load_dword v83, v10, s[40:43], 0 offen offset:3072 sc1
    s_waitcnt vmcnt(0)
    v_cmp_ne_u32 vcc, s65, v80
    v_cmp_ne_u32 s[86:87], s65, v81
    s_nop 0
    s_or_b64 vcc, vcc, s[86:87]
    v_cmp_ne_u32 s[86:87], s65, v82
    s_nop 0
    s_or_b64 vcc, vcc, s[86:87]
    v_cmp_ne_u32 s[86:87], s65, v83
    s_nop 0
    s_and_b32 s87, s87, 0
    s_or_b64 vcc, vcc, s[86:87]
    s_cbranch_vccz Lpd_14
    s_sleep 4
    s_add_u32 s90, s90, 1
    s_cmp_lt_u32 s90, 50000
    s_cbranch_scc1 Lpl_13
Lpd_14:
    s_mov_b64 exec, s[84:85]
Lpf_12:
    s_barrier
    s_lshl_b32 s71, s64, 10
    s_add_u32 m0, s71, 0
    s_mov_b32 s70, 0
    buffer_load_dwordx4 v5, s[40:43], s70 offen sc1 lds
    s_add_u32 m0, s71, 4096
    s_mov_b32 s70, 139264
    buffer_load_dwordx4 v5, s[40:43], s70 offen sc1 lds
    s_add_u32 m0, s71, 8192
    s_mov_b32 s70, 278528
    buffer_load_dwordx4 v5, s[40:43], s70 offen sc1 lds
    s_add_u32 m0, s71, 12288
    s_mov_b32 s70, 417792
    buffer_load_dwordx4 v5, s[40:43], s70 offen sc1 lds
    s_add_u32 m0, s71, 16384
    s_mov_b32 s70, 557056
    buffer_load_dwordx4 v5, s[40:43], s70 offen sc1 lds
    s_add_u32 m0, s71, 20480
    s_mov_b32 s70, 696320
    buffer_load_dwordx4 v5, s[40:43], s70 offen sc1 lds
    s_add_u32 m0, s71, 24576
    s_mov_b32 s70, 835584
    buffer_load_dwordx4 v5, s[40:43], s70 offen sc1 lds
    s_add_u32 m0, s71, 28672
    s_mov_b32 s70, 974848
    buffer_load_dwordx4 v5, s[40:43], s70 offen sc1 lds
    s_add_u32 m0, s71, 32768
    s_mov_b32 s70, 1114112
    buffer_load_dwordx4 v5, s[40:43], s70 offen sc1 lds
    s_add_u32 m0, s71, 36864
    s_mov_b32 s70, 1253376
    buffer_load_dwordx4 v5, s[40:43], s70 offen sc1 lds
    s_add_u32 m0, s71, 40960
    s_mov_b32 s70, 1392640
    buffer_load_dwordx4 v5, s[40:43], s70 offen sc1 lds
    s_add_u32 m0, s71, 45056
    s_mov_b32 s70, 1531904
    buffer_load_dwordx4 v5, s[40:43], s70 offen sc1 lds
    s_add_u32 m0, s71, 49152
    s_mov_b32 s70, 1671168
    buffer_load_dwordx4 v5, s[40:43], s70 offen sc1 lds
    s_add_u32 m0, s71, 53248
    s_mov_b32 s70, 1810432
    buffer_load_dwordx4 v5, s[40:43], s70 offen sc1 lds
    s_waitcnt vmcnt(0)
    s_barrier
    ds_read_b64_tr_b16 v[24:25], v8 offset:0
    ds_read_b64_tr_b16 v[26:27], v8 offset:2048
    ds_read_b64_tr_b16 v[28:29], v8 offset:4096
    ds_read_b64_tr_b16 v[30:31], v8 offset:6144
    ds_read_b64_tr_b16 v[32:33], v8 offset:8192
    ds_read_b64_tr_b16 v[34:35], v8 offset:10240
    ds_read_b64_tr_b16 v[36:37], v8 offset:12288
    ds_read_b64_tr_b16 v[38:39], v8 offset:14336
    ds_read_b64_tr_b16 v[40:41], v8 offset:16384
    ds_read_b64_tr_b16 v[42:43], v8 offset:18432
    ds_read_b64_tr_b16 v[44:45], v8 offset:20480
    ds_read_b64_tr_b16 v[46:47], v8 offset:22528
    ds_read_b64_tr_b16 v[48:49], v8 offset:24576
    ds_read_b64_tr_b16 v[50:51], v8 offset:26624
    ds_read_b64_tr_b16 v[52:53], v8 offset:28672
    ds_read_b64_tr_b16 v[54:55], v8 offset:30720
    ds_read_b64_tr_b16 v[56:57], v8 offset:32768
    ds_read_b64_tr_b16 v[58:59], v8 offset:34816
    ds_read_b64_tr_b16 v[60:61], v8 offset:36864
    ds_read_b64_tr_b16 v[62:63], v8 offset:38912
    ds_read_b64_tr_b16 v[64:65], v8 offset:40960
    ds_read_b64_tr_b16 v[66:67], v8 offset:43008
    ds_read_b64_tr_b16 v[68:69], v8 offset:45056
    ds_read_b64_tr_b16 v[70:71], v8 offset:47104
    ds_read_b64_tr_b16 v[72:73], v8 offset:49152
    ds_read_b64_tr_b16 v[74:75], v8 offset:51200
    ds_read_b64_tr_b16 v[76:77], v8 offset:53248
    ds_read_b64_tr_b16 v[78:79], v8 offset:55296
    s_waitcnt lgkmcnt(14)
    v_mfma_f32_16x16x32_bf16 v[16:19], v[24:27], v[24:27], 0
    v_mfma_f32_16x16x32_bf16 v[20:23], v[12:15], v[24:27], 0
    v_mfma_f32_16x16x32_bf16 v[16:19], v[28:31], v[28:31], v[16:19]
    v_mfma_f32_16x16x32_bf16 v[20:23], v[12:15], v[28:31], v[20:23]
    v_mfma_f32_16x16x32_bf16 v[16:19], v[32:35], v[32:35], v[16:19]
    v_mfma_f32_16x16x32_bf16 v[20:23], v[12:15], v[32:35], v[20:23]
    v_mfma_f32_16x16x32_bf16 v[16:19], v[36:39], v[36:39], v[16:19]
    v_mfma_f32_16x16x32_bf16 v[20:23], v[12:15], v[36:39], v[20:23]
    v_mfma_f32_16x16x32_bf16 v[16:19], v[40:43], v[40:43], v[16:19]
    v_mfma_f32_16x16x32_bf16 v[20:23], v[12:15], v[40:43], v[20:23]
    v_mfma_f32_16x16x32_bf16 v[16:19], v[44:47], v[44:47], v[16:19]
    v_mfma_f32_16x16x32_bf16 v[20:23], v[12:15], v[44:47], v[20:23]
    v_mfma_f32_16x16x32_bf16 v[16:19], v[48:51], v[48:51], v[16:19]
    v_mfma_f32_16x16x32_bf16 v[20:23], v[12:15], v[48:51], v[20:23]
    s_waitcnt lgkmcnt(12)
    v_mfma_f32_16x16x32_bf16 v[16:19], v[52:55], v[52:55], v[16:19]
    v_mfma_f32_16x16x32_bf16 v[20:23], v[12:15], v[52:55], v[20:23]
    s_waitcnt lgkmcnt(10)
    v_mfma_f32_16x16x32_bf16 v[16:19], v[56:59], v[56:59], v[16:19]
    v_mfma_f32_16x16x32_bf16 v[20:23], v[12:15], v[56:59], v[20:23]
    s_waitcnt lgkmcnt(8)
    v_mfma_f32_16x16x32_bf16 v[16:19], v[60:63], v[60:63], v[16:19]
    v_mfma_f32_16x16x32_bf16 v[20:23], v[12:15], v[60:63], v[20:23]
    s_waitcnt lgkmcnt(6)
    v_mfma_f32_16x16x32_bf16 v[16:19], v[64:67], v[64:67], v[16:19]
    v_mfma_f32_16x16x32_bf16 v[20:23], v[12:15], v[64:67], v[20:23]
    s_waitcnt lgkmcnt(4)
    v_mfma_f32_16x16x32_bf16 v[16:19], v[68:71], v[68:71], v[16:19]
    v_mfma_f32_16x16x32_bf16 v[20:23], v[12:15], v[68:71], v[20:23]
    s_waitcnt lgkmcnt(2)
    v_mfma_f32_16x16x32_bf16 v[16:19], v[72:75], v[72:75], v[16:19]
    v_mfma_f32_16x16x32_bf16 v[20:23], v[12:15], v[72:75], v[20:23]
    s_waitcnt lgkmcnt(0)
    v_mfma_f32_16x16x32_bf16 v[16:19], v[76:79], v[76:79], v[16:19]
    v_mfma_f32_16x16x32_bf16 v[20:23], v[12:15], v[76:79], v[20:23]
    s_nop 6
    v_cndmask_b32 v16, v16, v17, s[6:7]
    v_cndmask_b32 v16, v16, v18, s[8:9]
    v_cndmask_b32 v21, v16, v19, s[10:11]
    v_mul_f32 v20, 0x3b124925, v20
    v_mul_f32 v21, 0x3b124925, v21
    v_fma_f32 v21, -v20, v20, v21
    v_max_f32 v21, 0, v21
    v_cvt_pk_bf16_f32 v17, v20, v20
    v_lshlrev_b32 v17, 16, v17
    v_cvt_pk_bf16_f32 v19, v21, v21
    v_lshlrev_b32 v19, 16, v19
    v_add_f32 v19, 0x3727c5ac, v19
    v_cvt_pk_bf16_f32 v19, v19, v19
    v_lshlrev_b32 v19, 16, v19
    v_sqrt_f32 v19, v19
    s_nop 0
    v_cvt_pk_bf16_f32 v18, v19, v19
    v_lshlrev_b32 v18, 16, v18
    v_lshrrev_b32 v16, 16, v17
    v_or_b32 v16, v16, v18
    v_mov_b32 v17, s65
    v_and_b32 v3, 15, v1
    s_lshl_b32 s69, s91, 6
    s_lshl_b32 s70, s64, 4
    s_add_u32 s69, s69, s70
    v_add_u32 v3, s69, v3
    v_lshlrev_b32 v3, 3, v3
    v_add_u32 v3, 65536, v3
    s_mov_b64 s[84:85], exec
    s_mov_b64 exec, s[12:13]
    buffer_store_dwordx2 v[16:17], v3, s[40:43], 0 offen sc1
    s_mov_b64 exec, s[84:85]
    s_lshl_b32 s69, s64, 11
    v_add_u32 v6, s69, v6
    v_add_u32 v7, s69, v7
    ds_read_b64_tr_b16 v[80:81], v6 offset:0
    ds_read_b64_tr_b16 v[82:83], v6 offset:1024
    ds_read_b64_tr_b16 v[84:85], v7 offset:0
    ds_read_b64_tr_b16 v[86:87], v7 offset:1024
    ds_read_b64_tr_b16 v[88:89], v6 offset:8192
    ds_read_b64_tr_b16 v[90:91], v6 offset:9216
    ds_read_b64_tr_b16 v[92:93], v7 offset:8192
    ds_read_b64_tr_b16 v[94:95], v7 offset:9216
    ds_read_b64_tr_b16 v[96:97], v6 offset:16384
    ds_read_b64_tr_b16 v[98:99], v6 offset:17408
    ds_read_b64_tr_b16 v[100:101], v7 offset:16384
    ds_read_b64_tr_b16 v[102:103], v7 offset:17408
    ds_read_b64_tr_b16 v[104:105], v6 offset:24576
    ds_read_b64_tr_b16 v[106:107], v6 offset:25600
    ds_read_b64_tr_b16 v[108:109], v7 offset:24576
    ds_read_b64_tr_b16 v[110:111], v7 offset:25600
    ds_read_b64_tr_b16 v[112:113], v6 offset:32768
    ds_read_b64_tr_b16 v[114:115], v6 offset:33792
    ds_read_b64_tr_b16 v[116:117], v7 offset:32768
    ds_read_b64_tr_b16 v[118:119], v7 offset:33792
    ds_read_b64_tr_b16 v[120:121], v6 offset:40960
    ds_read_b64_tr_b16 v[122:123], v6 offset:41984
    ds_read_b64_tr_b16 v[124:125], v7 offset:40960
    ds_read_b64_tr_b16 v[126:127], v7 offset:41984
    ds_read_b64_tr_b16 v[128:129], v6 offset:49152
    ds_read_b64_tr_b16 v[130:131], v6 offset:50176
    ds_read_b64_tr_b16 v[132:133], v7 offset:49152
    ds_read_b64_tr_b16 v[134:135], v7 offset:50176
    s_waitcnt lgkmcnt(14)
    s_mov_b32 s70, 0
    buffer_store_dwordx4 v[80:83], v9, s[40:43], s70 offen sc1
    s_mov_b32 s70, 28672
    buffer_store_dwordx4 v[84:87], v9, s[40:43], s70 offen sc1
    s_mov_b32 s70, 4096
    buffer_store_dwordx4 v[88:91], v9, s[40:43], s70 offen sc1
    s_mov_b32 s70, 32768
    buffer_store_dwordx4 v[92:95], v9, s[40:43], s70 offen sc1
    s_mov_b32 s70, 8192
    buffer_store_dwordx4 v[96:99], v9, s[40:43], s70 offen sc1
    s_mov_b32 s70, 36864
    buffer_store_dwordx4 v[100:103], v9, s[40:43], s70 offen sc1
    s_mov_b32 s70, 12288
    buffer_store_dwordx4 v[104:107], v9, s[40:43], s70 offen sc1
    s_waitcnt lgkmcnt(12)
    s_mov_b32 s70, 40960
    buffer_store_dwordx4 v[108:111], v9, s[40:43], s70 offen sc1
    s_waitcnt lgkmcnt(10)
    s_mov_b32 s70, 16384
    buffer_store_dwordx4 v[112:115], v9, s[40:43], s70 offen sc1
    s_waitcnt lgkmcnt(8)
    s_mov_b32 s70, 45056
    buffer_store_dwordx4 v[116:119], v9, s[40:43], s70 offen sc1
    s_waitcnt lgkmcnt(6)
    s_mov_b32 s70, 20480
    buffer_store_dwordx4 v[120:123], v9, s[40:43], s70 offen sc1
    s_waitcnt lgkmcnt(4)
    s_mov_b32 s70, 49152
    buffer_store_dwordx4 v[124:127], v9, s[40:43], s70 offen sc1
    s_waitcnt lgkmcnt(2)
    s_mov_b32 s70, 24576
    buffer_store_dwordx4 v[128:131], v9, s[40:43], s70 offen sc1
    s_waitcnt lgkmcnt(0)
    s_mov_b32 s70, 53248
    buffer_store_dwordx4 v[132:135], v9, s[40:43], s70 offen sc1
    s_waitcnt vmcnt(0)
    s_barrier
    s_lshr_b32 s70, s91, 1
    s_lshl_b32 s70, s70, 4
    s_and_b32 s71, s91, 1
    s_add_u32 s70, s70, s71
    s_add_u32 s70, s70, 14
    s_cmp_lg_u32 s64, 0
    s_cbranch_scc1 Lsig_15
    s_mul_i32 s69, s70, 16
    s_add_u32 s69, s69, 49152
    v_mov_b32 v10, s65
    v_mov_b32 v11, s69
    s_mov_b64 s[84:85], exec
    s_mov_b64 exec, 1
    buffer_store_dword v10, v11, s[40:43], 0 offen sc1
    s_mov_b64 exec, s[84:85]
Lsig_15:
    s_branch L_end
L_worker:
    s_lshl_b32 s70, s68, 10
    v_lshl_add_u32 v8, v0, 2, s70
    s_lshl_b32 s69, s68, 2
    s_waitcnt lgkmcnt(0)
    global_load_dword v2, v8, s[6:7]
    global_load_dword v3, v8, s[8:9]
    global_load_dword v4, v8, s[10:11]
    global_load_dword v5, v8, s[12:13]
    global_load_dword v6, v8, s[14:15]
    global_load_dword v7, v8, s[16:17]
    s_load_dword s75, s[18:19], s69
    s_load_dword s76, s[20:21], s69
    s_mov_b32 s36, s4
    s_mov_b32 s37, s5
    s_mov_b32 s38, 0x1c0000
    s_mov_b32 s39, 0x20000
    s_mov_b32 s40, s34
    s_mov_b32 s41, s35
    s_mov_b32 s42, 0x2000000
    s_mov_b32 s43, 0x20000
    s_mov_b32 s44, s32
    s_mov_b32 s45, s33
    s_mov_b32 s46, 0x100
    s_mov_b32 s47, 0x20000
    s_mov_b32 s48, s24
    s_mov_b32 s49, s25
    s_mov_b32 s50, 0x188000
    s_mov_b32 s51, 0x20000
    s_mov_b32 s52, s26
    s_mov_b32 s53, s27
    s_mov_b32 s54, 0x188000
    s_mov_b32 s55, 0x20000
    s_mov_b32 s56, s28
    s_mov_b32 s57, s29
    s_mov_b32 s58, 0x188000
    s_mov_b32 s59, 0x20000
    s_mov_b32 s60, s30
    s_mov_b32 s61, s31
    s_mov_b32 s62, 0x1c0000
    s_mov_b32 s63, 0x20000
    s_mov_b32 s98, s82
    s_lshl_b32 s69, s68, 2
    v_mul_u32_u24 v18, 7168, v0
    v_add_u32 v18, s69, v18
    v_add_u32 v19, 4480, v18
    s_mul_i32 s69, s67, 37
    s_lshr_b32 s69, s69, 8
    s_lshr_b32 s77, s66, 1
    s_lshl_b32 s77, s77, 2
    s_add_u32 s77, s77, s69
    s_mul_i32 s69, s69, 7
    s_sub_u32 s78, s67, s69
    s_and_b32 s69, s66, 1
    s_mul_i32 s69, s69, 7
    s_add_u32 s78, s78, s69
    s_and_b32 s99, s77, 3
    s_mul_i32 s69, s67, 37
    s_lshr_b32 s69, s69, 8
    s_lshl_b32 s79, s66, 2
    s_add_u32 s79, s79, s69
    s_mul_i32 s69, s69, 7
    s_sub_u32 s80, s67, s69
    v_lshrrev_b32 v27, 4, v1
    v_mul_u32_u24 v26, 3584, v27
    v_lshlrev_b32 v27, 2, v27
    v_and_b32 v33, 15, v1
    v_xor_b32 v27, v27, v33
    v_lshl_add_u32 v26, v27, 4, v26
    s_lshl_b32 s69, s78, 8
    s_mul_i32 s70, s64, 14336
    s_add_u32 s69, s69, s70
    v_add_u32 v26, s69, v26
    s_lshl_b32 s81, s64, 10
    s_add_u32 s81, s81, 87040
    v_lshrrev_b32 v27, 5, v1
    v_lshlrev_b32 v28, 10, v27
    v_bfe_u32 v27, v1, 2, 2
    v_lshl_add_u32 v28, v27, 8, v28
    v_xor_b32 v27, s64, v27
    v_lshl_add_u32 v28, v27, 6, v28
    v_bfe_u32 v27, v1, 4, 1
    v_lshl_add_u32 v28, v27, 5, v28
    v_and_b32 v27, 3, v1
    v_lshl_add_u32 v28, v27, 3, v28
    v_add_u32 v29, 74496, v28
    v_add_u32 v30, 152576, v28
    v_add_u32 v31, 57344, v28
    v_mov_b32 v32, v28
    v_add_u32 v28, 87040, v28
    s_add_u32 s69, s99, 0
    s_and_b32 s69, s69, 3
    s_mul_i32 s14, s69, 401408
    s_add_u32 s69, s99, 1
    s_and_b32 s69, s69, 3
    s_mul_i32 s15, s69, 401408
    s_add_u32 s69, s99, 2
    s_and_b32 s69, s69, 3
    s_mul_i32 s16, s69, 401408
    s_add_u32 s69, s99, 3
    s_and_b32 s69, s69, 3
    s_mul_i32 s17, s69, 401408
    buffer_load_dword v10, v18, s[36:39], 0 offen offset:0
    buffer_load_dword v11, v18, s[36:39], 0 offen offset:896
    buffer_load_dword v12, v18, s[36:39], 0 offen offset:1792
    buffer_load_dword v13, v18, s[36:39], 0 offen offset:2688
    v_lshlrev_b32 v8, 3, v0
    v_sub_u32 v8, 2048, v8
    v_subrev_u32 v34, 1, v8
    v_subrev_u32 v35, 2, v8
    v_subrev_u32 v36, 3, v8
    v_subrev_u32 v37, 4, v8
    v_subrev_u32 v38, 5, v8
    v_subrev_u32 v39, 6, v8
    v_subrev_u32 v40, 7, v8
    v_subrev_u32 v41, 8, v8
    v_subrev_u32 v42, 9, v8
    v_subrev_u32 v43, 10, v8
    v_subrev_u32 v44, 11, v8
    v_mov_b32 v45, 0
    v_max_i32 v46, 0, v34
    v_max_i32 v47, 0, v35
    v_cvt_f32_u32 v46, v46
    v_cvt_f32_u32 v47, v47
    v_cvt_pk_bf16_f32 v9, v46, v47
    v_lshlrev_b32 v46, 16, v9
    v_and_b32 v47, 0xffff0000, v9
    v_cvt_u32_f32 v46, v46
    v_cvt_u32_f32 v47, v47
    v_lshrrev_b32 v9, 3, v46
    v_add_u32 v46, v46, v9
    v_lshlrev_b32 v46, 2, v46
    v_add_u32 v34, 55680, v46
    v_lshrrev_b32 v9, 3, v47
    v_add_u32 v47, v47, v9
    v_lshlrev_b32 v47, 2, v47
    v_add_u32 v35, 55680, v47
    v_max_i32 v46, 0, v36
    v_max_i32 v47, 0, v37
    v_cvt_f32_u32 v46, v46
    v_cvt_f32_u32 v47, v47
    v_cvt_pk_bf16_f32 v9, v46, v47
    v_lshlrev_b32 v46, 16, v9
    v_and_b32 v47, 0xffff0000, v9
    v_cvt_u32_f32 v46, v46
    v_cvt_u32_f32 v47, v47
    v_lshrrev_b32 v9, 3, v46
    v_add_u32 v46, v46, v9
    v_lshlrev_b32 v46, 2, v46
    v_add_u32 v36, 55680, v46
    v_lshrrev_b32 v9, 3, v47
    v_add_u32 v47, v47, v9
    v_lshlrev_b32 v47, 2, v47
    v_add_u32 v37, 55680, v47
    v_max_i32 v46, 0, v38
    v_max_i32 v47, 0, v39
    v_cvt_f32_u32 v46, v46
    v_cvt_f32_u32 v47, v47
    v_cvt_pk_bf16_f32 v9, v46, v47
    v_lshlrev_b32 v46, 16, v9
    v_and_b32 v47, 0xffff0000, v9
    v_cvt_u32_f32 v46, v46
    v_cvt_u32_f32 v47, v47
    v_lshrrev_b32 v9, 3, v46
    v_add_u32 v46, v46, v9
    v_lshlrev_b32 v46, 2, v46
    v_add_u32 v38, 55680, v46
    v_lshrrev_b32 v9, 3, v47
    v_add_u32 v47, v47, v9
    v_lshlrev_b32 v47, 2, v47
    v_add_u32 v39, 55680, v47
    v_max_i32 v46, 0, v40
    v_max_i32 v47, 0, v41
    v_cvt_f32_u32 v46, v46
    v_cvt_f32_u32 v47, v47
    v_cvt_pk_bf16_f32 v9, v46, v47
    v_lshlrev_b32 v46, 16, v9
    v_and_b32 v47, 0xffff0000, v9
    v_cvt_u32_f32 v46, v46
    v_cvt_u32_f32 v47, v47
    v_lshrrev_b32 v9, 3, v46
    v_add_u32 v46, v46, v9
    v_lshlrev_b32 v46, 2, v46
    v_add_u32 v40, 55680, v46
    v_lshrrev_b32 v9, 3, v47
    v_add_u32 v47, v47, v9
    v_lshlrev_b32 v47, 2, v47
    v_add_u32 v41, 55680, v47
    v_max_i32 v46, 0, v42
    v_max_i32 v47, 0, v43
    v_cvt_f32_u32 v46, v46
    v_cvt_f32_u32 v47, v47
    v_cvt_pk_bf16_f32 v9, v46, v47
    v_lshlrev_b32 v46, 16, v9
    v_and_b32 v47, 0xffff0000, v9
    v_cvt_u32_f32 v46, v46
    v_cvt_u32_f32 v47, v47
    v_lshrrev_b32 v9, 3, v46
    v_add_u32 v46, v46, v9
    v_cmp_gt_i32 vcc, 0, v42
    v_mov_b32 v9, 2320
    s_nop 0
    v_cndmask_b32 v46, v46, v9, vcc
    v_lshlrev_b32 v46, 2, v46
    v_add_u32 v42, 55680, v46
    v_lshrrev_b32 v9, 3, v47
    v_add_u32 v47, v47, v9
    v_cmp_gt_i32 vcc, 0, v43
    v_mov_b32 v9, 2320
    s_nop 0
    v_cndmask_b32 v47, v47, v9, vcc
    v_lshlrev_b32 v47, 2, v47
    v_add_u32 v43, 55680, v47
    v_max_i32 v46, 0, v44
    v_max_i32 v47, 0, v45
    v_cvt_f32_u32 v46, v46
    v_cvt_f32_u32 v47, v47
    v_cvt_pk_bf16_f32 v9, v46, v47
    v_lshlrev_b32 v46, 16, v9
    v_and_b32 v47, 0xffff0000, v9
    v_cvt_u32_f32 v46, v46
    v_cvt_u32_f32 v47, v47
    v_lshrrev_b32 v9, 3, v46
    v_add_u32 v46, v46, v9
    v_cmp_gt_i32 vcc, 0, v44
    v_mov_b32 v9, 2320
    s_nop 0
    v_cndmask_b32 v46, v46, v9, vcc
    v_lshlrev_b32 v46, 2, v46
    v_add_u32 v44, 55680, v46
    v_lshrrev_b32 v9, 3, v47
    v_add_u32 v47, v47, v9
    v_cmp_gt_i32 vcc, 0, v45
    v_mov_b32 v9, 2320
    s_nop 0
    v_cndmask_b32 v47, v47, v9, vcc
    v_lshlrev_b32 v47, 2, v47
    v_add_u32 v45, 55680, v47
    s_waitcnt lgkmcnt(0)
    s_lshr_b32 s69, s64, 1
    s_lshl_b32 s69, s69, 4
    s_lshr_b32 s75, s75, s69
    s_lshl_b32 s75, s75, 16
    s_lshr_b32 s76, s76, s69
    s_lshl_b32 s76, s76, 16
    v_mov_b32 v46, s75
    v_mul_f32 v48, 0x3fb8aa3b, v46
    s_mov_b32 s70, 0x3fb8aa3b
    v_fma_f32 v49, v46, s70, -v48
    v_fmac_f32 v49, 0x32a57060, v46
    v_exp_f32 v48, v48
    v_mul_f32 v49, 0x3f317218, v49
    v_fma_f32 v46, v48, v49, v48
    v_cvt_pk_bf16_f32 v46, v46, v46
    v_lshlrev_b32 v46, 16, v46
    s_lshr_b32 s69, s64, 1
    s_mul_i32 s69, s69, 19584
    s_and_b32 s70, s64, 1
    s_lshl_b32 s70, s70, 9
    s_add_u32 s69, s69, s70
    v_lshrrev_b32 v49, 4, v1
    v_lshlrev_b32 v48, 4, v49
    v_add_u32 v48, s69, v48
    v_and_b32 v49, 3, v1
    v_mul_u32_u24 v49, 1088, v49
    v_add_u32 v27, v48, v49
    v_bfe_u32 v49, v1, 2, 2
    v_mul_u32_u24 v49, 1088, v49
    v_add_u32 v33, v48, v49
    s_lshl_b32 s69, s64, 12
    s_add_u32 s69, s69, 39168
    v_lshl_add_u32 v50, v1, 4, s69
    s_xor_b32 s70, s64, 1
    s_lshl_b32 s69, s70, 12
    s_add_u32 s69, s69, 39168
    v_lshl_add_u32 v51, v1, 4, s69
    s_lshl_b32 s69, s64, 2
    s_add_u32 s69, s69, 55552
    v_mov_b32 v52, s69
    s_lshl_b32 s69, s70, 2
    s_add_u32 s69, s69, 55552
    v_mov_b32 v53, s69
    v_and_b32 v54, 15, v1
    v_lshrrev_b32 v49, 3, v54
    v_add_u32 v54, v54, v49
    v_lshrrev_b32 v49, 4, v1
    v_mul_u32_u24 v49, 144, v49
    v_add_u32 v54, v54, v49
    v_lshlrev_b32 v54, 2, v54
    s_lshr_b32 s69, s64, 1
    s_mul_i32 s69, s69, 9344
    s_add_u32 s69, s69, 55680
    v_mov_b32 v55, s69
    s_and_b32 s70, s64, 1
    s_mul_i32 s70, s70, 4608
    s_add_u32 s70, s70, s69
    v_add_u32 v54, s70, v54
    s_lshr_b32 s69, s64, 1
    s_mul_i32 s69, s69, 16640
    s_and_b32 s70, s64, 1
    s_lshl_b32 s71, s70, 9
    s_sub_u32 s69, s69, s71
    s_add_u32 s69, s69, 536
    v_and_b32 v64, 3, v1
    v_mul_u32_u24 v49, 4160, v64
    v_bfe_u32 v64, v1, 2, 2
    v_lshlrev_b32 v64, 3, v64
    v_sub_u32 v49, v49, v64
    v_lshrrev_b32 v64, 4, v1
    v_lshl_add_u32 v49, v64, 4, v49
    v_add_u32 v49, s69, v49
    s_lshr_b32 s69, s64, 1
    s_mul_i32 s69, s69, 5120
    s_add_u32 s69, s69, 33280
    s_lshl_b32 s70, s70, 3
    v_lshrrev_b32 v66, 4, v1
    v_and_b32 v67, 15, v1
    v_subrev_u32 v67, s70, v67
    v_add_u32 v64, 16, v67
    v_bfe_u32 v65, v64, 2, 1
    v_lshlrev_b32 v65, 1, v65
    v_xor_b32 v65, v65, v66
    v_lshlrev_b32 v64, 6, v64
    v_lshl_add_u32 v64, v65, 4, v64
    v_add_u32 v56, s69, v64
    v_add_u32 v64, 15, v67
    v_bfe_u32 v65, v64, 2, 1
    v_lshlrev_b32 v65, 1, v65
    v_xor_b32 v65, v65, v66
    v_lshlrev_b32 v64, 6, v64
    v_lshl_add_u32 v64, v65, 4, v64
    v_add_u32 v57, s69, v64
    v_add_u32 v64, 14, v67
    v_bfe_u32 v65, v64, 2, 1
    v_lshlrev_b32 v65, 1, v65
    v_xor_b32 v65, v65, v66
    v_lshlrev_b32 v64, 6, v64
    v_lshl_add_u32 v64, v65, 4, v64
    v_add_u32 v58, s69, v64
    v_add_u32 v64, 13, v67
    v_bfe_u32 v65, v64, 2, 1
    v_lshlrev_b32 v65, 1, v65
    v_xor_b32 v65, v65, v66
    v_lshlrev_b32 v64, 6, v64
    v_lshl_add_u32 v64, v65, 4, v64
    v_add_u32 v59, s69, v64
    v_add_u32 v64, 12, v67
    v_bfe_u32 v65, v64, 2, 1
    v_lshlrev_b32 v65, 1, v65
    v_xor_b32 v65, v65, v66
    v_lshlrev_b32 v64, 6, v64
    v_lshl_add_u32 v64, v65, 4, v64
    v_add_u32 v60, s69, v64
    v_add_u32 v64, 11, v67
    v_bfe_u32 v65, v64, 2, 1
    v_lshlrev_b32 v65, 1, v65
    v_xor_b32 v65, v65, v66
    v_lshlrev_b32 v64, 6, v64
    v_lshl_add_u32 v64, v65, 4, v64
    v_add_u32 v61, s69, v64
    v_add_u32 v64, 10, v67
    v_bfe_u32 v65, v64, 2, 1
    v_lshlrev_b32 v65, 1, v65
    v_xor_b32 v65, v65, v66
    v_lshlrev_b32 v64, 6, v64
    v_lshl_add_u32 v64, v65, 4, v64
    v_add_u32 v62, s69, v64
    v_add_u32 v64, 9, v67
    v_bfe_u32 v65, v64, 2, 1
    v_lshlrev_b32 v65, 1, v65
    v_xor_b32 v65, v65, v66
    v_lshlrev_b32 v64, 6, v64
    v_lshl_add_u32 v64, v65, 4, v64
    v_add_u32 v63, s69, v64
    v_bfe_u32 v64, v1, 2, 1
    v_lshlrev_b32 v64, 1, v64
    v_lshrrev_b32 v65, 4, v1
    v_xor_b32 v64, v64, v65
    v_and_b32 v65, 15, v1
    v_lshlrev_b32 v65, 6, v65
    v_lshl_add_u32 v66, v64, 4, v65
    s_and_b32 s70, s64, 1
    s_lshl_b32 s70, s70, 11
    s_lshr_b32 s69, s64, 1
    s_mul_i32 s71, s69, 5120
    s_add_u32 s71, s71, s70
    s_mul_i32 s72, s69, 4096
    s_add_u32 s72, s72, s70
    v_add_u32 v67, s72, v66
    v_add_u32 v66, s71, v66
    v_lshrrev_b32 v64, 4, v1
    v_lshl_add_u32 v70, v64, 4, v65
    s_lshl_b32 s71, s68, 1
    s_add_u32 s71, s71, s69
    s_mul_i32 s71, s71, 4352
    s_add_u32 s71, s71, s70
    s_add_u32 s71, s71, 131072
    v_add_u32 v70, s71, v70
    s_lshl_b32 s69, s64, 12
    s_add_u32 s69, s69, 55680
    v_lshl_add_u32 v68, v1, 4, s69
    s_xor_b32 s69, s64, 1
    s_lshl_b32 s69, s69, 12
    s_add_u32 s69, s69, 55680
    v_lshl_add_u32 v69, v1, 4, s69
    s_lshr_b32 s69, s68, 2
    s_lshl_b32 s69, s69, 15
    s_and_b32 s70, s68, 3
    s_lshl_b32 s70, s70, 5
    s_add_u32 s69, s69, s70
    s_add_u32 s69, s69, 11534336
    v_lshl_add_u32 v64, v0, 7, s69
    v_lshlrev_b32 v65, 6, v0
    v_mov_b32 v73, 0
    v_and_b32 v75, 31, v1
    v_lshlrev_b32 v75, 7, v75
    s_lshl_b32 s69, s64, 12
    s_add_u32 s69, s69, 4
    v_add_u32 v75, s69, v75
    buffer_load_dword v14, v18, s[36:39], 0 offen offset:3584
    s_waitcnt vmcnt(5)
    v_lshlrev_b32 v80, 16, v4
    v_and_b32 v82, 0xffff0000, v4
    v_lshlrev_b32 v81, 16, v5
    v_and_b32 v83, 0xffff0000, v5
    v_lshlrev_b32 v84, 16, v6
    v_and_b32 v86, 0xffff0000, v6
    v_lshlrev_b32 v85, 16, v7
    v_and_b32 v87, 0xffff0000, v7
    v_mul_f32 v80, v46, v80
    v_mul_f32 v81, v46, v81
    v_mul_f32 v82, v46, v82
    v_mul_f32 v83, v46, v83
    v_pk_mul_f32 v[92:93], v[84:85], v[80:81] op_sel:[0,0] op_sel_hi:[0,1]
    v_pk_mul_f32 v[94:95], v[86:87], v[82:83] op_sel:[0,0] op_sel_hi:[0,1]
    v_lshlrev_b32 v76, 16, v2
    v_and_b32 v77, 0xffff0000, v2
    v_lshlrev_b32 v78, 16, v3
    v_and_b32 v79, 0xffff0000, v3
    v_pk_fma_f32 v[92:93], v[84:85], v[80:81], v[92:93] op_sel:[1,1,0] op_sel_hi:[1,0,1] neg_lo:[0,1,0]
    v_pk_fma_f32 v[94:95], v[86:87], v[82:83], v[94:95] op_sel:[1,1,0] op_sel_hi:[1,0,1] neg_lo:[0,1,0]
    v_max_f32 v2, |v92|, |v93|
    v_max_f32 v3, |v94|, |v95|
    v_max_f32 v2, v2, v3
    v_mul_f32 v78, v46, v78
    v_mul_f32 v76, v46, v76
    v_max_f32_dpp v2, v2, v2 quad_perm:[1,0,3,2] row_mask:0xf bank_mask:0xf
    v_mul_f32 v79, v46, v79
    v_mul_f32 v78, 0x3e22f983, v78
    v_max_f32_dpp v2, v2, v2 quad_perm:[2,3,0,1] row_mask:0xf bank_mask:0xf
    v_mul_f32 v77, v46, v77
    v_mul_f32 v76, 0x3fb8aa3b, v76
    v_max_f32_dpp v2, v2, v2 row_half_mirror row_mask:0xf bank_mask:0xf
    v_mul_f32 v79, 0x3e22f983, v79
    v_fract_f32 v6, v78
    v_max_f32_dpp v2, v2, v2 row_mirror row_mask:0xf bank_mask:0xf
    v_mov_b32 v3, v2
    v_mul_f32 v77, 0x3fb8aa3b, v77
    v_exp_f32 v4, v76
    v_permlane16_swap_b32 v2, v3
    v_max_f32 v2, v2, v3
    v_mov_b32 v3, v2
    v_fract_f32 v7, v79
    v_cos_f32 v96, v6
    v_permlane32_swap_b32 v2, v3
    v_max_f32 v2, v2, v3
    v_sin_f32 v97, v6
    v_readfirstlane_b32 s69, v2
    v_and_b32 v2, 127, v0
    s_lshr_b32 s69, s69, 23
    s_max_u32 s69, s69, 14
    s_min_u32 s69, s69, 254
    s_sub_u32 s70, 267, s69
    s_lshl_b32 s70, s70, 23
    s_sub_u32 s101, s69, 13
    s_lshl_b32 s101, s101, 23
    s_lshr_b32 s69, s64, 1
    v_lshlrev_b32 v2, 3, v2
    s_mul_i32 s69, s69, 19584
    v_exp_f32 v5, v77
    v_cos_f32 v98, v7
    v_sin_f32 v99, v7
    buffer_load_dword v15, v19, s[36:39], 0 offen offset:0
    v_add_u32 v2, s69, v2
    v_mov_b32 v46, 0x3c00
    v_mov_b32 v47, 0x3c00
    v_mul_f32 v96, v4, v96
    v_mul_f32 v97, v4, v97
    ds_write_b64 v2, v[46:47] offset:0
    v_mul_f32 v98, v5, v98
    v_mul_f32 v99, v5, v99
    v_pk_mul_f32 v[100:101], v[96:97], v[96:97] op_sel:[0,0] op_sel_hi:[0,1]
    ds_write_b64 v2, v[46:47] offset:4352
    v_pk_mul_f32 v[102:103], v[98:99], v[98:99] op_sel:[0,0] op_sel_hi:[0,1]
    v_pk_fma_f32 v[100:101], v[96:97], v[96:97], v[100:101] op_sel:[1,1,0] op_sel_hi:[1,0,1] neg_lo:[0,1,0]
    ds_write_b64 v2, v[46:47] offset:13056
    v_cvt_pk_f16_f32 v88, v96, v97
    v_cvt_pk_f16_f32 v89, v98, v99
    v_mul_f32 v112, s70, v92
    v_mul_f32 v113, s70, v93
    v_mul_f32 v114, s70, v94
    v_mul_f32 v115, s70, v95
    v_pk_fma_f32 v[102:103], v[98:99], v[98:99], v[102:103] op_sel:[1,1,0] op_sel_hi:[1,0,1] neg_lo:[0,1,0]
    v_pk_mul_f32 v[104:105], v[100:101], v[96:97] op_sel:[0,0] op_sel_hi:[0,1]
    v_pk_mul_f32 v[108:109], v[100:101], v[100:101] op_sel:[0,0] op_sel_hi:[0,1]
    ds_write_b64 v2, v[88:89] offset:1088
    v_cvt_pk_f16_f32 v90, v112, -v113
    v_cvt_pk_f16_f32 v91, v114, -v115
    v_pk_mul_f32 v[106:107], v[102:103], v[98:99] op_sel:[0,0] op_sel_hi:[0,1]
    v_pk_fma_f32 v[104:105], v[100:101], v[96:97], v[104:105] op_sel:[1,1,0] op_sel_hi:[1,0,1] neg_lo:[0,1,0]
    v_pk_mul_f32 v[110:111], v[102:103], v[102:103] op_sel:[0,0] op_sel_hi:[0,1]
    v_pk_fma_f32 v[108:109], v[100:101], v[100:101], v[108:109] op_sel:[1,1,0] op_sel_hi:[1,0,1] neg_lo:[0,1,0]
    ds_write_b64 v2, v[90:91] offset:8704
    v_cvt_pk_f16_f32 v88, v100, v101
    v_cvt_pk_f16_f32 v89, v102, v103
    v_pk_fma_f32 v[106:107], v[102:103], v[98:99], v[106:107] op_sel:[1,1,0] op_sel_hi:[1,0,1] neg_lo:[0,1,0]
    v_pk_fma_f32 v[110:111], v[102:103], v[102:103], v[110:111] op_sel:[1,1,0] op_sel_hi:[1,0,1] neg_lo:[0,1,0]
    v_pk_mul_f32 v[96:97], v[108:109], v[108:109] op_sel:[0,0] op_sel_hi:[0,1]
    ds_write_b64 v2, v[88:89] offset:2176
    v_cvt_pk_f16_f32 v90, v104, v105
    v_cvt_pk_f16_f32 v91, v106, v107
    v_pk_mul_f32 v[98:99], v[110:111], v[110:111] op_sel:[0,0] op_sel_hi:[0,1]
    v_pk_fma_f32 v[96:97], v[108:109], v[108:109], v[96:97] op_sel:[1,1,0] op_sel_hi:[1,0,1] neg_lo:[0,1,0]
    ds_write_b64 v2, v[90:91] offset:3264
    v_pk_fma_f32 v[98:99], v[110:111], v[110:111], v[98:99] op_sel:[1,1,0] op_sel_hi:[1,0,1] neg_lo:[0,1,0]
    v_pk_mul_f32 v[100:101], v[96:97], v[108:109] op_sel:[0,0] op_sel_hi:[0,1]
    v_pk_mul_f32 v[104:105], v[96:97], v[96:97] op_sel:[0,0] op_sel_hi:[0,1]
    v_cvt_pk_f16_f32 v88, v108, v109
    v_cvt_pk_f16_f32 v89, v110, v111
    v_cvt_pk_f16_f32 v90, v96, v97
    v_pk_mul_f32 v[102:103], v[98:99], v[110:111] op_sel:[0,0] op_sel_hi:[0,1]
    v_pk_fma_f32 v[100:101], v[96:97], v[108:109], v[100:101] op_sel:[1,1,0] op_sel_hi:[1,0,1] neg_lo:[0,1,0]
    v_pk_mul_f32 v[106:107], v[98:99], v[98:99] op_sel:[0,0] op_sel_hi:[0,1]
    v_pk_fma_f32 v[104:105], v[96:97], v[96:97], v[104:105] op_sel:[1,1,0] op_sel_hi:[1,0,1] neg_lo:[0,1,0]
    ds_write_b64 v2, v[88:89] offset:5440
    v_cvt_pk_f16_f32 v91, v98, v99
    v_pk_fma_f32 v[102:103], v[98:99], v[110:111], v[102:103] op_sel:[1,1,0] op_sel_hi:[1,0,1] neg_lo:[0,1,0]
    v_pk_fma_f32 v[106:107], v[98:99], v[98:99], v[106:107] op_sel:[1,1,0] op_sel_hi:[1,0,1] neg_lo:[0,1,0]
    v_pk_mul_f32 v[96:97], v[104:105], v[104:105] op_sel:[0,0] op_sel_hi:[0,1]
    v_cvt_pk_f16_f32 v88, v100, v101
    v_pk_mul_f32 v[98:99], v[106:107], v[106:107] op_sel:[0,0] op_sel_hi:[0,1]
    v_pk_fma_f32 v[96:97], v[104:105], v[104:105], v[96:97] op_sel:[1,1,0] op_sel_hi:[1,0,1] neg_lo:[0,1,0]
    ds_write_b64 v2, v[90:91] offset:6528
    v_cvt_pk_f16_f32 v89, v102, v103
    v_pk_fma_f32 v[98:99], v[106:107], v[106:107], v[98:99] op_sel:[1,1,0] op_sel_hi:[1,0,1] neg_lo:[0,1,0]
    v_pk_mul_f32 v[108:109], v[112:113], v[96:97] op_sel:[0,0] op_sel_hi:[0,1]
    v_pk_mul_f32 v[100:101], v[96:97], v[96:97] op_sel:[0,0] op_sel_hi:[0,1]
    ds_write_b64 v2, v[88:89] offset:7616
    v_cvt_pk_f16_f32 v90, v104, v105
    v_pk_mul_f32 v[110:111], v[114:115], v[98:99] op_sel:[0,0] op_sel_hi:[0,1]
    v_pk_fma_f32 v[108:109], v[112:113], v[96:97], v[108:109] op_sel:[1,1,0] op_sel_hi:[1,0,1] neg_lo:[0,1,0]
    v_pk_fma_f32 v[100:101], v[96:97], v[96:97], v[100:101] op_sel:[1,1,0] op_sel_hi:[1,0,1] neg_lo:[0,1,0]
    v_pk_fma_f32 v[110:111], v[114:115], v[98:99], v[110:111] op_sel:[1,1,0] op_sel_hi:[1,0,1] neg_lo:[0,1,0]
    v_cvt_pk_f16_f32 v88, v108, -v109
    v_pk_mul_f32 v[102:103], v[98:99], v[98:99] op_sel:[0,0] op_sel_hi:[0,1]
    v_pk_mul_f32 v[104:105], v[100:101], v[96:97] op_sel:[0,0] op_sel_hi:[0,1]
    v_cvt_pk_f16_f32 v91, v106, v107
    v_cvt_pk_f16_f32 v89, v110, -v111
    v_pk_fma_f32 v[102:103], v[98:99], v[98:99], v[102:103] op_sel:[1,1,0] op_sel_hi:[1,0,1] neg_lo:[0,1,0]
    v_pk_mul_f32 v[108:109], v[112:113], v[100:101] op_sel:[0,0] op_sel_hi:[0,1]
    v_pk_fma_f32 v[104:105], v[100:101], v[96:97], v[104:105] op_sel:[1,1,0] op_sel_hi:[1,0,1] neg_lo:[0,1,0]
    ds_write_b64 v2, v[90:91] offset:17408
    v_pk_mul_f32 v[110:111], v[114:115], v[102:103] op_sel:[0,0] op_sel_hi:[0,1]
    v_pk_fma_f32 v[108:109], v[112:113], v[100:101], v[108:109] op_sel:[1,1,0] op_sel_hi:[1,0,1] neg_lo:[0,1,0]
    v_pk_mul_f32 v[106:107], v[102:103], v[98:99] op_sel:[0,0] op_sel_hi:[0,1]
    v_pk_mul_f32 v[96:97], v[100:101], v[100:101] op_sel:[0,0] op_sel_hi:[0,1]
    v_pk_fma_f32 v[110:111], v[114:115], v[102:103], v[110:111] op_sel:[1,1,0] op_sel_hi:[1,0,1] neg_lo:[0,1,0]
    v_cvt_pk_f16_f32 v90, v108, -v109
    v_pk_fma_f32 v[106:107], v[102:103], v[98:99], v[106:107] op_sel:[1,1,0] op_sel_hi:[1,0,1] neg_lo:[0,1,0]
    v_pk_fma_f32 v[96:97], v[100:101], v[100:101], v[96:97] op_sel:[1,1,0] op_sel_hi:[1,0,1] neg_lo:[0,1,0]
    v_cvt_pk_f16_f32 v91, v110, -v111
    v_pk_mul_f32 v[108:109], v[112:113], v[104:105] op_sel:[0,0] op_sel_hi:[0,1]
    v_pk_mul_f32 v[98:99], v[102:103], v[102:103] op_sel:[0,0] op_sel_hi:[0,1]
    v_pk_mul_f32 v[100:101], v[96:97], v[96:97] op_sel:[0,0] op_sel_hi:[0,1]
    ds_write_b64 v2, v[88:89] offset:9792
    v_pk_mul_f32 v[110:111], v[114:115], v[106:107] op_sel:[0,0] op_sel_hi:[0,1]
    v_pk_fma_f32 v[108:109], v[112:113], v[104:105], v[108:109] op_sel:[1,1,0] op_sel_hi:[1,0,1] neg_lo:[0,1,0]
    v_pk_fma_f32 v[98:99], v[102:103], v[102:103], v[98:99] op_sel:[1,1,0] op_sel_hi:[1,0,1] neg_lo:[0,1,0]
    v_pk_fma_f32 v[100:101], v[96:97], v[96:97], v[100:101] op_sel:[1,1,0] op_sel_hi:[1,0,1] neg_lo:[0,1,0]
    ds_write_b64 v2, v[90:91] offset:10880
    v_pk_fma_f32 v[110:111], v[114:115], v[106:107], v[110:111] op_sel:[1,1,0] op_sel_hi:[1,0,1] neg_lo:[0,1,0]
    v_pk_mul_f32 v[102:103], v[98:99], v[98:99] op_sel:[0,0] op_sel_hi:[0,1]
    v_pk_mul_f32 v[104:105], v[100:101], v[96:97] op_sel:[0,0] op_sel_hi:[0,1]
    v_cvt_pk_f16_f32 v88, v108, -v109
    v_cvt_pk_f16_f32 v89, v110, -v111
    v_cvt_pk_f16_f32 v90, v96, -v97
    v_pk_fma_f32 v[102:103], v[98:99], v[98:99], v[102:103] op_sel:[1,1,0] op_sel_hi:[1,0,1] neg_lo:[0,1,0]
    v_pk_fma_f32 v[104:105], v[100:101], v[96:97], v[104:105] op_sel:[1,1,0] op_sel_hi:[1,0,1] neg_lo:[0,1,0]
    ds_write_b64 v2, v[88:89] offset:11968
    v_pk_mul_f32 v[106:107], v[102:103], v[98:99] op_sel:[0,0] op_sel_hi:[0,1]
    v_pk_mul_f32 v[96:97], v[100:101], v[100:101] op_sel:[0,0] op_sel_hi:[0,1]
    v_cvt_pk_f16_f32 v91, v98, -v99
    v_cvt_pk_f16_f32 v88, v100, -v101
    v_pk_fma_f32 v[106:107], v[102:103], v[98:99], v[106:107] op_sel:[1,1,0] op_sel_hi:[1,0,1] neg_lo:[0,1,0]
    v_pk_fma_f32 v[96:97], v[100:101], v[100:101], v[96:97] op_sel:[1,1,0] op_sel_hi:[1,0,1] neg_lo:[0,1,0]
    ds_write_b64 v2, v[90:91] offset:14144
    v_pk_mul_f32 v[98:99], v[102:103], v[102:103] op_sel:[0,0] op_sel_hi:[0,1]
    v_pk_mul_f32 v[100:101], v[96:97], v[96:97] op_sel:[0,0] op_sel_hi:[0,1]
    v_cvt_pk_f16_f32 v89, v102, -v103
    v_cvt_pk_f16_f32 v90, v104, -v105
    v_pk_fma_f32 v[98:99], v[102:103], v[102:103], v[98:99] op_sel:[1,1,0] op_sel_hi:[1,0,1] neg_lo:[0,1,0]
    v_pk_fma_f32 v[100:101], v[96:97], v[96:97], v[100:101] op_sel:[1,1,0] op_sel_hi:[1,0,1] neg_lo:[0,1,0]
    v_pk_mul_f32 v[102:103], v[98:99], v[98:99] op_sel:[0,0] op_sel_hi:[0,1]
    v_pk_mul_f32 v[104:105], v[100:101], v[100:101] op_sel:[0,0] op_sel_hi:[0,1]
    v_cvt_pk_f16_f32 v91, v106, -v107
    v_pk_fma_f32 v[102:103], v[98:99], v[98:99], v[102:103] op_sel:[1,1,0] op_sel_hi:[1,0,1] neg_lo:[0,1,0]
    v_pk_fma_f32 v[104:105], v[100:101], v[100:101], v[104:105] op_sel:[1,1,0] op_sel_hi:[1,0,1] neg_lo:[0,1,0]
    v_pk_mul_f32 v[106:107], v[102:103], v[102:103] op_sel:[0,0] op_sel_hi:[0,1]
    v_mul_f32 v46, v92, v104
    v_pk_fma_f32 v[106:107], v[102:103], v[102:103], v[106:107] op_sel:[1,1,0] op_sel_hi:[1,0,1] neg_lo:[0,1,0]
    v_fma_f32 v46, -v93, v105, v46
    v_fmac_f32 v46, v94, v106
    v_fma_f32 v46, -v95, v107, v46
    ds_write_b64 v2, v[88:89] offset:15232
    ds_write_b64 v2, v[90:91] offset:16320
    v_add_f32_dpp v46, v46, v46 quad_perm:[1,0,3,2] row_mask:0xf bank_mask:0xf
    v_cvt_pk_f16_f32 v88, v96, -v97
    v_cvt_pk_f16_f32 v89, v98, -v99
    v_add_f32_dpp v46, v46, v46 quad_perm:[2,3,0,1] row_mask:0xf bank_mask:0xf
    ds_write_b64 v2, v[88:89] offset:18496
    buffer_load_dword v16, v19, s[36:39], 0 offen offset:896
    v_add_f32_dpp v46, v46, v46 row_half_mirror row_mask:0xf bank_mask:0xf
    s_nop 1
    v_add_f32_dpp v46, v46, v46 row_mirror row_mask:0xf bank_mask:0xf
    v_mov_b32 v47, v46
    s_nop 1
    v_permlane16_swap_b32 v46, v47
    v_add_f32 v46, v46, v47
    v_mov_b32 v47, v46
    s_nop 1
    v_permlane32_swap_b32 v46, v47
    v_add_f32 v46, v46, v47
    s_waitcnt lgkmcnt(0)
    s_barrier
    ds_read_b128 v[4:7], v27 offset:0
    ds_read_b128 v[100:103], v33 offset:4352
    ds_read_b128 v[104:107], v48 offset:17408
    ds_read_b128 v[108:111], v27 offset:8704
    ds_read_b128 v[112:115], v33 offset:13056
    ds_read_b128 v[116:119], v48 offset:18496
    s_waitcnt lgkmcnt(0)
    v_pk_mul_f16 v144, v4, v100 op_sel:[0,0] op_sel_hi:[0,1]
    v_pk_mul_f16 v145, v5, v101 op_sel:[0,0] op_sel_hi:[0,1]
    v_pk_mul_f16 v146, v6, v102 op_sel:[0,0] op_sel_hi:[0,1]
    v_pk_mul_f16 v147, v7, v103 op_sel:[0,0] op_sel_hi:[0,1]
    v_pk_fma_f16 v148, v4, v100, v144 op_sel:[1,1,0] op_sel_hi:[1,0,1] neg_lo:[0,1,0]
    v_pk_fma_f16 v149, v5, v101, v145 op_sel:[1,1,0] op_sel_hi:[1,0,1] neg_lo:[0,1,0]
    v_pk_fma_f16 v150, v6, v102, v146 op_sel:[1,1,0] op_sel_hi:[1,0,1] neg_lo:[0,1,0]
    v_pk_fma_f16 v151, v7, v103, v147 op_sel:[1,1,0] op_sel_hi:[1,0,1] neg_lo:[0,1,0]
    v_pk_mul_f16 v144, v148, v104 op_sel:[0,0] op_sel_hi:[0,1]
    v_pk_mul_f16 v145, v149, v105 op_sel:[0,0] op_sel_hi:[0,1]
    v_pk_mul_f16 v146, v150, v106 op_sel:[0,0] op_sel_hi:[0,1]
    v_pk_mul_f16 v147, v151, v107 op_sel:[0,0] op_sel_hi:[0,1]
    v_pk_fma_f16 v152, v148, v104, v144 op_sel:[1,1,0] op_sel_hi:[1,0,1] neg_lo:[0,1,0]
    v_pk_fma_f16 v153, v149, v105, v145 op_sel:[1,1,0] op_sel_hi:[1,0,1] neg_lo:[0,1,0]
    v_pk_fma_f16 v154, v150, v106, v146 op_sel:[1,1,0] op_sel_hi:[1,0,1] neg_lo:[0,1,0]
    v_pk_fma_f16 v155, v151, v107, v147 op_sel:[1,1,0] op_sel_hi:[1,0,1] neg_lo:[0,1,0]
    v_pk_mul_f16 v144, v108, v112 op_sel:[0,0] op_sel_hi:[0,1]
    v_pk_mul_f16 v145, v109, v113 op_sel:[0,0] op_sel_hi:[0,1]
    v_pk_mul_f16 v146, v110, v114 op_sel:[0,0] op_sel_hi:[0,1]
    v_pk_mul_f16 v147, v111, v115 op_sel:[0,0] op_sel_hi:[0,1]
    v_pk_fma_f16 v164, v108, v112, v144 op_sel:[1,1,0] op_sel_hi:[1,0,1] neg_lo:[0,1,0]
    v_pk_fma_f16 v165, v109, v113, v145 op_sel:[1,1,0] op_sel_hi:[1,0,1] neg_lo:[0,1,0]
    v_pk_fma_f16 v166, v110, v114, v146 op_sel:[1,1,0] op_sel_hi:[1,0,1] neg_lo:[0,1,0]
    v_pk_fma_f16 v167, v111, v115, v147 op_sel:[1,1,0] op_sel_hi:[1,0,1] neg_lo:[0,1,0]
    v_pk_mul_f16 v144, v164, v116 op_sel:[0,0] op_sel_hi:[0,1]
    v_pk_mul_f16 v145, v165, v117 op_sel:[0,0] op_sel_hi:[0,1]
    v_mfma_f32_16x16x32_f16 v[180:183], v[164:167], v[148:151], 0
    ds_read_b128 v[120:123], v27 offset:64
    ds_read_b128 v[124:127], v33 offset:4416
    v_pk_mul_f16 v146, v166, v118 op_sel:[0,0] op_sel_hi:[0,1]
    v_pk_mul_f16 v147, v167, v119 op_sel:[0,0] op_sel_hi:[0,1]
    v_pk_fma_f16 v168, v164, v116, v144 op_sel:[1,1,0] op_sel_hi:[1,0,1] neg_lo:[0,1,0]
    v_pk_fma_f16 v169, v165, v117, v145 op_sel:[1,1,0] op_sel_hi:[1,0,1] neg_lo:[0,1,0]
    v_mfma_f32_16x16x32_f16 v[184:187], v[164:167], v[152:155], 0
    ds_read_b128 v[128:131], v48 offset:17472
    ds_read_b128 v[132:135], v27 offset:8768
    v_pk_fma_f16 v170, v166, v118, v146 op_sel:[1,1,0] op_sel_hi:[1,0,1] neg_lo:[0,1,0]
    v_pk_fma_f16 v171, v167, v119, v147 op_sel:[1,1,0] op_sel_hi:[1,0,1] neg_lo:[0,1,0]
    v_pk_mul_f16 v144, v168, v116 op_sel:[0,0] op_sel_hi:[0,1]
    v_pk_mul_f16 v145, v169, v117 op_sel:[0,0] op_sel_hi:[0,1]
    v_mfma_f32_16x16x32_f16 v[188:191], v[168:171], v[148:151], 0
    ds_read_b128 v[136:139], v33 offset:13120
    ds_read_b128 v[140:143], v48 offset:18560
    v_pk_mul_f16 v146, v170, v118 op_sel:[0,0] op_sel_hi:[0,1]
    v_pk_mul_f16 v147, v171, v119 op_sel:[0,0] op_sel_hi:[0,1]
    v_pk_fma_f16 v172, v168, v116, v144 op_sel:[1,1,0] op_sel_hi:[1,0,1] neg_lo:[0,1,0]
    v_pk_fma_f16 v173, v169, v117, v145 op_sel:[1,1,0] op_sel_hi:[1,0,1] neg_lo:[0,1,0]
    v_mfma_f32_16x16x32_f16 v[192:195], v[168:171], v[152:155], 0
    v_pk_fma_f16 v174, v170, v118, v146 op_sel:[1,1,0] op_sel_hi:[1,0,1] neg_lo:[0,1,0]
    v_pk_fma_f16 v175, v171, v119, v147 op_sel:[1,1,0] op_sel_hi:[1,0,1] neg_lo:[0,1,0]
    v_pk_mul_f16 v144, v172, v116 op_sel:[0,0] op_sel_hi:[0,1]
    v_pk_mul_f16 v145, v173, v117 op_sel:[0,0] op_sel_hi:[0,1]
    v_mfma_f32_16x16x32_f16 v[196:199], v[172:175], v[148:151], 0
    v_pk_mul_f16 v146, v174, v118 op_sel:[0,0] op_sel_hi:[0,1]
    v_pk_mul_f16 v147, v175, v119 op_sel:[0,0] op_sel_hi:[0,1]
    v_pk_fma_f16 v176, v172, v116, v144 op_sel:[1,1,0] op_sel_hi:[1,0,1] neg_lo:[0,1,0]
    v_pk_fma_f16 v177, v173, v117, v145 op_sel:[1,1,0] op_sel_hi:[1,0,1] neg_lo:[0,1,0]
    v_mfma_f32_16x16x32_f16 v[200:203], v[172:175], v[152:155], 0
    v_pk_fma_f16 v178, v174, v118, v146 op_sel:[1,1,0] op_sel_hi:[1,0,1] neg_lo:[0,1,0]
    v_pk_fma_f16 v179, v175, v119, v147 op_sel:[1,1,0] op_sel_hi:[1,0,1] neg_lo:[0,1,0]
    s_waitcnt lgkmcnt(0)
    v_pk_mul_f16 v144, v120, v124 op_sel:[0,0] op_sel_hi:[0,1]
    v_pk_mul_f16 v145, v121, v125 op_sel:[0,0] op_sel_hi:[0,1]
    v_mfma_f32_16x16x32_f16 v[204:207], v[176:179], v[148:151], 0
    ds_read_b128 v[4:7], v27 offset:128
    ds_read_b128 v[100:103], v33 offset:4480
    v_pk_mul_f16 v146, v122, v126 op_sel:[0,0] op_sel_hi:[0,1]
    v_pk_mul_f16 v147, v123, v127 op_sel:[0,0] op_sel_hi:[0,1]
    v_pk_fma_f16 v156, v120, v124, v144 op_sel:[1,1,0] op_sel_hi:[1,0,1] neg_lo:[0,1,0]
    v_pk_fma_f16 v157, v121, v125, v145 op_sel:[1,1,0] op_sel_hi:[1,0,1] neg_lo:[0,1,0]
    v_mfma_f32_16x16x32_f16 v[208:211], v[176:179], v[152:155], 0
    ds_read_b128 v[104:107], v48 offset:17536
    ds_read_b128 v[108:111], v27 offset:8832
    v_pk_fma_f16 v158, v122, v126, v146 op_sel:[1,1,0] op_sel_hi:[1,0,1] neg_lo:[0,1,0]
    v_pk_fma_f16 v159, v123, v127, v147 op_sel:[1,1,0] op_sel_hi:[1,0,1] neg_lo:[0,1,0]
    v_pk_mul_f16 v144, v156, v128 op_sel:[0,0] op_sel_hi:[0,1]
    v_pk_mul_f16 v145, v157, v129 op_sel:[0,0] op_sel_hi:[0,1]
    v_pk_mul_f16 v146, v158, v130 op_sel:[0,0] op_sel_hi:[0,1]
    v_pk_mul_f16 v147, v159, v131 op_sel:[0,0] op_sel_hi:[0,1]
    v_pk_fma_f16 v160, v156, v128, v144 op_sel:[1,1,0] op_sel_hi:[1,0,1] neg_lo:[0,1,0]
    v_pk_fma_f16 v161, v157, v129, v145 op_sel:[1,1,0] op_sel_hi:[1,0,1] neg_lo:[0,1,0]
    v_pk_fma_f16 v162, v158, v130, v146 op_sel:[1,1,0] op_sel_hi:[1,0,1] neg_lo:[0,1,0]
    v_pk_fma_f16 v163, v159, v131, v147 op_sel:[1,1,0] op_sel_hi:[1,0,1] neg_lo:[0,1,0]
    v_pk_mul_f16 v144, v132, v136 op_sel:[0,0] op_sel_hi:[0,1]
    v_pk_mul_f16 v145, v133, v137 op_sel:[0,0] op_sel_hi:[0,1]
    v_pk_mul_f16 v146, v134, v138 op_sel:[0,0] op_sel_hi:[0,1]
    v_pk_mul_f16 v147, v135, v139 op_sel:[0,0] op_sel_hi:[0,1]
    v_pk_fma_f16 v164, v132, v136, v144 op_sel:[1,1,0] op_sel_hi:[1,0,1] neg_lo:[0,1,0]
    v_pk_fma_f16 v165, v133, v137, v145 op_sel:[1,1,0] op_sel_hi:[1,0,1] neg_lo:[0,1,0]
    v_pk_fma_f16 v166, v134, v138, v146 op_sel:[1,1,0] op_sel_hi:[1,0,1] neg_lo:[0,1,0]
    v_pk_fma_f16 v167, v135, v139, v147 op_sel:[1,1,0] op_sel_hi:[1,0,1] neg_lo:[0,1,0]
    v_pk_mul_f16 v144, v164, v140 op_sel:[0,0] op_sel_hi:[0,1]
    v_pk_mul_f16 v145, v165, v141 op_sel:[0,0] op_sel_hi:[0,1]
    v_mfma_f32_16x16x32_f16 v[180:183], v[164:167], v[156:159], v[180:183]
    ds_read_b128 v[112:115], v33 offset:13184
    ds_read_b128 v[116:119], v48 offset:18624
    v_pk_mul_f16 v146, v166, v142 op_sel:[0,0] op_sel_hi:[0,1]
    v_pk_mul_f16 v147, v167, v143 op_sel:[0,0] op_sel_hi:[0,1]
    v_pk_fma_f16 v168, v164, v140, v144 op_sel:[1,1,0] op_sel_hi:[1,0,1] neg_lo:[0,1,0]
    v_pk_fma_f16 v169, v165, v141, v145 op_sel:[1,1,0] op_sel_hi:[1,0,1] neg_lo:[0,1,0]
    v_mfma_f32_16x16x32_f16 v[184:187], v[164:167], v[160:163], v[184:187]
    buffer_load_dword v17, v19, s[36:39], 0 offen offset:1792
    v_pk_fma_f16 v170, v166, v142, v146 op_sel:[1,1,0] op_sel_hi:[1,0,1] neg_lo:[0,1,0]
    v_pk_fma_f16 v171, v167, v143, v147 op_sel:[1,1,0] op_sel_hi:[1,0,1] neg_lo:[0,1,0]
    v_pk_mul_f16 v144, v168, v140 op_sel:[0,0] op_sel_hi:[0,1]
    v_pk_mul_f16 v145, v169, v141 op_sel:[0,0] op_sel_hi:[0,1]
    v_mfma_f32_16x16x32_f16 v[188:191], v[168:171], v[156:159], v[188:191]
    v_pk_mul_f16 v146, v170, v142 op_sel:[0,0] op_sel_hi:[0,1]
    v_pk_mul_f16 v147, v171, v143 op_sel:[0,0] op_sel_hi:[0,1]
    v_pk_fma_f16 v172, v168, v140, v144 op_sel:[1,1,0] op_sel_hi:[1,0,1] neg_lo:[0,1,0]
    v_pk_fma_f16 v173, v169, v141, v145 op_sel:[1,1,0] op_sel_hi:[1,0,1] neg_lo:[0,1,0]
    v_mfma_f32_16x16x32_f16 v[192:195], v[168:171], v[160:163], v[192:195]
    v_pk_fma_f16 v174, v170, v142, v146 op_sel:[1,1,0] op_sel_hi:[1,0,1] neg_lo:[0,1,0]
    v_pk_fma_f16 v175, v171, v143, v147 op_sel:[1,1,0] op_sel_hi:[1,0,1] neg_lo:[0,1,0]
    v_pk_mul_f16 v144, v172, v140 op_sel:[0,0] op_sel_hi:[0,1]
    v_pk_mul_f16 v145, v173, v141 op_sel:[0,0] op_sel_hi:[0,1]
    v_mfma_f32_16x16x32_f16 v[196:199], v[172:175], v[156:159], v[196:199]
    v_pk_mul_f16 v146, v174, v142 op_sel:[0,0] op_sel_hi:[0,1]
    v_pk_mul_f16 v147, v175, v143 op_sel:[0,0] op_sel_hi:[0,1]
    v_pk_fma_f16 v176, v172, v140, v144 op_sel:[1,1,0] op_sel_hi:[1,0,1] neg_lo:[0,1,0]
    v_pk_fma_f16 v177, v173, v141, v145 op_sel:[1,1,0] op_sel_hi:[1,0,1] neg_lo:[0,1,0]
    v_mfma_f32_16x16x32_f16 v[200:203], v[172:175], v[160:163], v[200:203]
    v_pk_fma_f16 v178, v174, v142, v146 op_sel:[1,1,0] op_sel_hi:[1,0,1] neg_lo:[0,1,0]
    v_pk_fma_f16 v179, v175, v143, v147 op_sel:[1,1,0] op_sel_hi:[1,0,1] neg_lo:[0,1,0]
    s_waitcnt lgkmcnt(0)
    v_pk_mul_f16 v144, v4, v100 op_sel:[0,0] op_sel_hi:[0,1]
    v_pk_mul_f16 v145, v5, v101 op_sel:[0,0] op_sel_hi:[0,1]
    v_mfma_f32_16x16x32_f16 v[204:207], v[176:179], v[156:159], v[204:207]
    ds_read_b128 v[120:123], v27 offset:192
    ds_read_b128 v[124:127], v33 offset:4544
    v_pk_mul_f16 v146, v6, v102 op_sel:[0,0] op_sel_hi:[0,1]
    v_pk_mul_f16 v147, v7, v103 op_sel:[0,0] op_sel_hi:[0,1]
    v_pk_fma_f16 v148, v4, v100, v144 op_sel:[1,1,0] op_sel_hi:[1,0,1] neg_lo:[0,1,0]
    v_pk_fma_f16 v149, v5, v101, v145 op_sel:[1,1,0] op_sel_hi:[1,0,1] neg_lo:[0,1,0]
    v_mfma_f32_16x16x32_f16 v[208:211], v[176:179], v[160:163], v[208:211]
    ds_read_b128 v[128:131], v48 offset:17600
    ds_read_b128 v[132:135], v27 offset:8896
    v_pk_fma_f16 v150, v6, v102, v146 op_sel:[1,1,0] op_sel_hi:[1,0,1] neg_lo:[0,1,0]
    v_pk_fma_f16 v151, v7, v103, v147 op_sel:[1,1,0] op_sel_hi:[1,0,1] neg_lo:[0,1,0]
    v_pk_mul_f16 v144, v148, v104 op_sel:[0,0] op_sel_hi:[0,1]
    v_pk_mul_f16 v145, v149, v105 op_sel:[0,0] op_sel_hi:[0,1]
    v_pk_mul_f16 v146, v150, v106 op_sel:[0,0] op_sel_hi:[0,1]
    v_pk_mul_f16 v147, v151, v107 op_sel:[0,0] op_sel_hi:[0,1]
    v_pk_fma_f16 v152, v148, v104, v144 op_sel:[1,1,0] op_sel_hi:[1,0,1] neg_lo:[0,1,0]
    v_pk_fma_f16 v153, v149, v105, v145 op_sel:[1,1,0] op_sel_hi:[1,0,1] neg_lo:[0,1,0]
    v_pk_fma_f16 v154, v150, v106, v146 op_sel:[1,1,0] op_sel_hi:[1,0,1] neg_lo:[0,1,0]
    v_pk_fma_f16 v155, v151, v107, v147 op_sel:[1,1,0] op_sel_hi:[1,0,1] neg_lo:[0,1,0]
    v_pk_mul_f16 v144, v108, v112 op_sel:[0,0] op_sel_hi:[0,1]
    v_pk_mul_f16 v145, v109, v113 op_sel:[0,0] op_sel_hi:[0,1]
    v_pk_mul_f16 v146, v110, v114 op_sel:[0,0] op_sel_hi:[0,1]
    v_pk_mul_f16 v147, v111, v115 op_sel:[0,0] op_sel_hi:[0,1]
    v_pk_fma_f16 v164, v108, v112, v144 op_sel:[1,1,0] op_sel_hi:[1,0,1] neg_lo:[0,1,0]
    v_pk_fma_f16 v165, v109, v113, v145 op_sel:[1,1,0] op_sel_hi:[1,0,1] neg_lo:[0,1,0]
    v_pk_fma_f16 v166, v110, v114, v146 op_sel:[1,1,0] op_sel_hi:[1,0,1] neg_lo:[0,1,0]
    v_pk_fma_f16 v167, v111, v115, v147 op_sel:[1,1,0] op_sel_hi:[1,0,1] neg_lo:[0,1,0]
    v_pk_mul_f16 v144, v164, v116 op_sel:[0,0] op_sel_hi:[0,1]
    v_pk_mul_f16 v145, v165, v117 op_sel:[0,0] op_sel_hi:[0,1]
    v_mfma_f32_16x16x32_f16 v[180:183], v[164:167], v[148:151], v[180:183]
    ds_read_b128 v[136:139], v33 offset:13248
    ds_read_b128 v[140:143], v48 offset:18688
    v_pk_mul_f16 v146, v166, v118 op_sel:[0,0] op_sel_hi:[0,1]
    v_pk_mul_f16 v147, v167, v119 op_sel:[0,0] op_sel_hi:[0,1]
    v_pk_fma_f16 v168, v164, v116, v144 op_sel:[1,1,0] op_sel_hi:[1,0,1] neg_lo:[0,1,0]
    v_pk_fma_f16 v169, v165, v117, v145 op_sel:[1,1,0] op_sel_hi:[1,0,1] neg_lo:[0,1,0]
    v_mfma_f32_16x16x32_f16 v[184:187], v[164:167], v[152:155], v[184:187]
    v_pk_fma_f16 v170, v166, v118, v146 op_sel:[1,1,0] op_sel_hi:[1,0,1] neg_lo:[0,1,0]
    v_pk_fma_f16 v171, v167, v119, v147 op_sel:[1,1,0] op_sel_hi:[1,0,1] neg_lo:[0,1,0]
    v_pk_mul_f16 v144, v168, v116 op_sel:[0,0] op_sel_hi:[0,1]
    v_pk_mul_f16 v145, v169, v117 op_sel:[0,0] op_sel_hi:[0,1]
    v_mfma_f32_16x16x32_f16 v[188:191], v[168:171], v[148:151], v[188:191]
    v_pk_mul_f16 v146, v170, v118 op_sel:[0,0] op_sel_hi:[0,1]
    v_pk_mul_f16 v147, v171, v119 op_sel:[0,0] op_sel_hi:[0,1]
    v_pk_fma_f16 v172, v168, v116, v144 op_sel:[1,1,0] op_sel_hi:[1,0,1] neg_lo:[0,1,0]
    v_pk_fma_f16 v173, v169, v117, v145 op_sel:[1,1,0] op_sel_hi:[1,0,1] neg_lo:[0,1,0]
    v_mfma_f32_16x16x32_f16 v[192:195], v[168:171], v[152:155], v[192:195]
    v_pk_fma_f16 v174, v170, v118, v146 op_sel:[1,1,0] op_sel_hi:[1,0,1] neg_lo:[0,1,0]
    v_pk_fma_f16 v175, v171, v119, v147 op_sel:[1,1,0] op_sel_hi:[1,0,1] neg_lo:[0,1,0]
    v_pk_mul_f16 v144, v172, v116 op_sel:[0,0] op_sel_hi:[0,1]
    v_pk_mul_f16 v145, v173, v117 op_sel:[0,0] op_sel_hi:[0,1]
    v_mfma_f32_16x16x32_f16 v[196:199], v[172:175], v[148:151], v[196:199]
    v_pk_mul_f16 v146, v174, v118 op_sel:[0,0] op_sel_hi:[0,1]
    v_pk_mul_f16 v147, v175, v119 op_sel:[0,0] op_sel_hi:[0,1]
    v_pk_fma_f16 v176, v172, v116, v144 op_sel:[1,1,0] op_sel_hi:[1,0,1] neg_lo:[0,1,0]
    v_pk_fma_f16 v177, v173, v117, v145 op_sel:[1,1,0] op_sel_hi:[1,0,1] neg_lo:[0,1,0]
    v_mfma_f32_16x16x32_f16 v[200:203], v[172:175], v[152:155], v[200:203]
    v_pk_fma_f16 v178, v174, v118, v146 op_sel:[1,1,0] op_sel_hi:[1,0,1] neg_lo:[0,1,0]
    v_pk_fma_f16 v179, v175, v119, v147 op_sel:[1,1,0] op_sel_hi:[1,0,1] neg_lo:[0,1,0]
    s_waitcnt lgkmcnt(0)
    v_pk_mul_f16 v144, v120, v124 op_sel:[0,0] op_sel_hi:[0,1]
    v_pk_mul_f16 v145, v121, v125 op_sel:[0,0] op_sel_hi:[0,1]
    v_mfma_f32_16x16x32_f16 v[204:207], v[176:179], v[148:151], v[204:207]
    ds_read_b128 v[4:7], v27 offset:256
    ds_read_b128 v[100:103], v33 offset:4608
    v_pk_mul_f16 v146, v122, v126 op_sel:[0,0] op_sel_hi:[0,1]
    v_pk_mul_f16 v147, v123, v127 op_sel:[0,0] op_sel_hi:[0,1]
    v_pk_fma_f16 v156, v120, v124, v144 op_sel:[1,1,0] op_sel_hi:[1,0,1] neg_lo:[0,1,0]
    v_pk_fma_f16 v157, v121, v125, v145 op_sel:[1,1,0] op_sel_hi:[1,0,1] neg_lo:[0,1,0]
    v_mfma_f32_16x16x32_f16 v[208:211], v[176:179], v[152:155], v[208:211]
    ds_read_b128 v[104:107], v48 offset:17664
    ds_read_b128 v[108:111], v27 offset:8960
    v_pk_fma_f16 v158, v122, v126, v146 op_sel:[1,1,0] op_sel_hi:[1,0,1] neg_lo:[0,1,0]
    v_pk_fma_f16 v159, v123, v127, v147 op_sel:[1,1,0] op_sel_hi:[1,0,1] neg_lo:[0,1,0]
    v_pk_mul_f16 v144, v156, v128 op_sel:[0,0] op_sel_hi:[0,1]
    v_pk_mul_f16 v145, v157, v129 op_sel:[0,0] op_sel_hi:[0,1]
    v_pk_mul_f16 v146, v158, v130 op_sel:[0,0] op_sel_hi:[0,1]
    v_pk_mul_f16 v147, v159, v131 op_sel:[0,0] op_sel_hi:[0,1]
    v_pk_fma_f16 v160, v156, v128, v144 op_sel:[1,1,0] op_sel_hi:[1,0,1] neg_lo:[0,1,0]
    v_pk_fma_f16 v161, v157, v129, v145 op_sel:[1,1,0] op_sel_hi:[1,0,1] neg_lo:[0,1,0]
    v_pk_fma_f16 v162, v158, v130, v146 op_sel:[1,1,0] op_sel_hi:[1,0,1] neg_lo:[0,1,0]
    v_pk_fma_f16 v163, v159, v131, v147 op_sel:[1,1,0] op_sel_hi:[1,0,1] neg_lo:[0,1,0]
    v_pk_mul_f16 v144, v132, v136 op_sel:[0,0] op_sel_hi:[0,1]
    v_pk_mul_f16 v145, v133, v137 op_sel:[0,0] op_sel_hi:[0,1]
    v_pk_mul_f16 v146, v134, v138 op_sel:[0,0] op_sel_hi:[0,1]
    v_pk_mul_f16 v147, v135, v139 op_sel:[0,0] op_sel_hi:[0,1]
    v_pk_fma_f16 v164, v132, v136, v144 op_sel:[1,1,0] op_sel_hi:[1,0,1] neg_lo:[0,1,0]
    v_pk_fma_f16 v165, v133, v137, v145 op_sel:[1,1,0] op_sel_hi:[1,0,1] neg_lo:[0,1,0]
    v_pk_fma_f16 v166, v134, v138, v146 op_sel:[1,1,0] op_sel_hi:[1,0,1] neg_lo:[0,1,0]
    v_pk_fma_f16 v167, v135, v139, v147 op_sel:[1,1,0] op_sel_hi:[1,0,1] neg_lo:[0,1,0]
    v_pk_mul_f16 v144, v164, v140 op_sel:[0,0] op_sel_hi:[0,1]
    v_pk_mul_f16 v145, v165, v141 op_sel:[0,0] op_sel_hi:[0,1]
    v_mfma_f32_16x16x32_f16 v[180:183], v[164:167], v[156:159], v[180:183]
    ds_read_b128 v[112:115], v33 offset:13312
    ds_read_b128 v[116:119], v48 offset:18752
    v_pk_mul_f16 v146, v166, v142 op_sel:[0,0] op_sel_hi:[0,1]
    v_pk_mul_f16 v147, v167, v143 op_sel:[0,0] op_sel_hi:[0,1]
    v_pk_fma_f16 v168, v164, v140, v144 op_sel:[1,1,0] op_sel_hi:[1,0,1] neg_lo:[0,1,0]
    v_pk_fma_f16 v169, v165, v141, v145 op_sel:[1,1,0] op_sel_hi:[1,0,1] neg_lo:[0,1,0]
    v_mfma_f32_16x16x32_f16 v[184:187], v[164:167], v[160:163], v[184:187]
    v_pk_fma_f16 v170, v166, v142, v146 op_sel:[1,1,0] op_sel_hi:[1,0,1] neg_lo:[0,1,0]
    v_pk_fma_f16 v171, v167, v143, v147 op_sel:[1,1,0] op_sel_hi:[1,0,1] neg_lo:[0,1,0]
    v_pk_mul_f16 v144, v168, v140 op_sel:[0,0] op_sel_hi:[0,1]
    v_pk_mul_f16 v145, v169, v141 op_sel:[0,0] op_sel_hi:[0,1]
    v_mfma_f32_16x16x32_f16 v[188:191], v[168:171], v[156:159], v[188:191]
    v_pk_mul_f16 v146, v170, v142 op_sel:[0,0] op_sel_hi:[0,1]
    v_pk_mul_f16 v147, v171, v143 op_sel:[0,0] op_sel_hi:[0,1]
    v_pk_fma_f16 v172, v168, v140, v144 op_sel:[1,1,0] op_sel_hi:[1,0,1] neg_lo:[0,1,0]
    v_pk_fma_f16 v173, v169, v141, v145 op_sel:[1,1,0] op_sel_hi:[1,0,1] neg_lo:[0,1,0]
    v_mfma_f32_16x16x32_f16 v[192:195], v[168:171], v[160:163], v[192:195]
    v_pk_fma_f16 v174, v170, v142, v146 op_sel:[1,1,0] op_sel_hi:[1,0,1] neg_lo:[0,1,0]
    v_pk_fma_f16 v175, v171, v143, v147 op_sel:[1,1,0] op_sel_hi:[1,0,1] neg_lo:[0,1,0]
    v_pk_mul_f16 v144, v172, v140 op_sel:[0,0] op_sel_hi:[0,1]
    v_pk_mul_f16 v145, v173, v141 op_sel:[0,0] op_sel_hi:[0,1]
    v_mfma_f32_16x16x32_f16 v[196:199], v[172:175], v[156:159], v[196:199]
    v_pk_mul_f16 v146, v174, v142 op_sel:[0,0] op_sel_hi:[0,1]
    v_pk_mul_f16 v147, v175, v143 op_sel:[0,0] op_sel_hi:[0,1]
    v_pk_fma_f16 v176, v172, v140, v144 op_sel:[1,1,0] op_sel_hi:[1,0,1] neg_lo:[0,1,0]
    v_pk_fma_f16 v177, v173, v141, v145 op_sel:[1,1,0] op_sel_hi:[1,0,1] neg_lo:[0,1,0]
    v_mfma_f32_16x16x32_f16 v[200:203], v[172:175], v[160:163], v[200:203]
    v_pk_fma_f16 v178, v174, v142, v146 op_sel:[1,1,0] op_sel_hi:[1,0,1] neg_lo:[0,1,0]
    v_pk_fma_f16 v179, v175, v143, v147 op_sel:[1,1,0] op_sel_hi:[1,0,1] neg_lo:[0,1,0]
    s_waitcnt lgkmcnt(0)
    v_pk_mul_f16 v144, v4, v100 op_sel:[0,0] op_sel_hi:[0,1]
    v_pk_mul_f16 v145, v5, v101 op_sel:[0,0] op_sel_hi:[0,1]
    v_mfma_f32_16x16x32_f16 v[204:207], v[176:179], v[156:159], v[204:207]
    ds_read_b128 v[120:123], v27 offset:320
    ds_read_b128 v[124:127], v33 offset:4672
    v_pk_mul_f16 v146, v6, v102 op_sel:[0,0] op_sel_hi:[0,1]
    v_pk_mul_f16 v147, v7, v103 op_sel:[0,0] op_sel_hi:[0,1]
    v_pk_fma_f16 v148, v4, v100, v144 op_sel:[1,1,0] op_sel_hi:[1,0,1] neg_lo:[0,1,0]
    v_pk_fma_f16 v149, v5, v101, v145 op_sel:[1,1,0] op_sel_hi:[1,0,1] neg_lo:[0,1,0]
    v_mfma_f32_16x16x32_f16 v[208:211], v[176:179], v[160:163], v[208:211]
    ds_read_b128 v[128:131], v48 offset:17728
    ds_read_b128 v[132:135], v27 offset:9024
    v_pk_fma_f16 v150, v6, v102, v146 op_sel:[1,1,0] op_sel_hi:[1,0,1] neg_lo:[0,1,0]
    v_pk_fma_f16 v151, v7, v103, v147 op_sel:[1,1,0] op_sel_hi:[1,0,1] neg_lo:[0,1,0]
    v_pk_mul_f16 v144, v148, v104 op_sel:[0,0] op_sel_hi:[0,1]
    v_pk_mul_f16 v145, v149, v105 op_sel:[0,0] op_sel_hi:[0,1]
    v_pk_mul_f16 v146, v150, v106 op_sel:[0,0] op_sel_hi:[0,1]
    v_pk_mul_f16 v147, v151, v107 op_sel:[0,0] op_sel_hi:[0,1]
    v_pk_fma_f16 v152, v148, v104, v144 op_sel:[1,1,0] op_sel_hi:[1,0,1] neg_lo:[0,1,0]
    v_pk_fma_f16 v153, v149, v105, v145 op_sel:[1,1,0] op_sel_hi:[1,0,1] neg_lo:[0,1,0]
    v_pk_fma_f16 v154, v150, v106, v146 op_sel:[1,1,0] op_sel_hi:[1,0,1] neg_lo:[0,1,0]
    v_pk_fma_f16 v155, v151, v107, v147 op_sel:[1,1,0] op_sel_hi:[1,0,1] neg_lo:[0,1,0]
    v_pk_mul_f16 v144, v108, v112 op_sel:[0,0] op_sel_hi:[0,1]
    v_pk_mul_f16 v145, v109, v113 op_sel:[0,0] op_sel_hi:[0,1]
    v_pk_mul_f16 v146, v110, v114 op_sel:[0,0] op_sel_hi:[0,1]
    v_pk_mul_f16 v147, v111, v115 op_sel:[0,0] op_sel_hi:[0,1]
    v_pk_fma_f16 v164, v108, v112, v144 op_sel:[1,1,0] op_sel_hi:[1,0,1] neg_lo:[0,1,0]
    v_pk_fma_f16 v165, v109, v113, v145 op_sel:[1,1,0] op_sel_hi:[1,0,1] neg_lo:[0,1,0]
    v_pk_fma_f16 v166, v110, v114, v146 op_sel:[1,1,0] op_sel_hi:[1,0,1] neg_lo:[0,1,0]
    v_pk_fma_f16 v167, v111, v115, v147 op_sel:[1,1,0] op_sel_hi:[1,0,1] neg_lo:[0,1,0]
    v_pk_mul_f16 v144, v164, v116 op_sel:[0,0] op_sel_hi:[0,1]
    v_pk_mul_f16 v145, v165, v117 op_sel:[0,0] op_sel_hi:[0,1]
    v_mfma_f32_16x16x32_f16 v[180:183], v[164:167], v[148:151], v[180:183]
    ds_read_b128 v[136:139], v33 offset:13376
    ds_read_b128 v[140:143], v48 offset:18816
    v_pk_mul_f16 v146, v166, v118 op_sel:[0,0] op_sel_hi:[0,1]
    v_pk_mul_f16 v147, v167, v119 op_sel:[0,0] op_sel_hi:[0,1]
    v_pk_fma_f16 v168, v164, v116, v144 op_sel:[1,1,0] op_sel_hi:[1,0,1] neg_lo:[0,1,0]
    v_pk_fma_f16 v169, v165, v117, v145 op_sel:[1,1,0] op_sel_hi:[1,0,1] neg_lo:[0,1,0]
    v_mfma_f32_16x16x32_f16 v[184:187], v[164:167], v[152:155], v[184:187]
    v_pk_fma_f16 v170, v166, v118, v146 op_sel:[1,1,0] op_sel_hi:[1,0,1] neg_lo:[0,1,0]
    v_pk_fma_f16 v171, v167, v119, v147 op_sel:[1,1,0] op_sel_hi:[1,0,1] neg_lo:[0,1,0]
    v_pk_mul_f16 v144, v168, v116 op_sel:[0,0] op_sel_hi:[0,1]
    v_pk_mul_f16 v145, v169, v117 op_sel:[0,0] op_sel_hi:[0,1]
    v_mfma_f32_16x16x32_f16 v[188:191], v[168:171], v[148:151], v[188:191]
    v_pk_mul_f16 v146, v170, v118 op_sel:[0,0] op_sel_hi:[0,1]
    v_pk_mul_f16 v147, v171, v119 op_sel:[0,0] op_sel_hi:[0,1]
    v_pk_fma_f16 v172, v168, v116, v144 op_sel:[1,1,0] op_sel_hi:[1,0,1] neg_lo:[0,1,0]
    v_pk_fma_f16 v173, v169, v117, v145 op_sel:[1,1,0] op_sel_hi:[1,0,1] neg_lo:[0,1,0]
    v_mfma_f32_16x16x32_f16 v[192:195], v[168:171], v[152:155], v[192:195]
    v_pk_fma_f16 v174, v170, v118, v146 op_sel:[1,1,0] op_sel_hi:[1,0,1] neg_lo:[0,1,0]
    v_pk_fma_f16 v175, v171, v119, v147 op_sel:[1,1,0] op_sel_hi:[1,0,1] neg_lo:[0,1,0]
    v_pk_mul_f16 v144, v172, v116 op_sel:[0,0] op_sel_hi:[0,1]
    v_pk_mul_f16 v145, v173, v117 op_sel:[0,0] op_sel_hi:[0,1]
    v_mfma_f32_16x16x32_f16 v[196:199], v[172:175], v[148:151], v[196:199]
    v_pk_mul_f16 v146, v174, v118 op_sel:[0,0] op_sel_hi:[0,1]
    v_pk_mul_f16 v147, v175, v119 op_sel:[0,0] op_sel_hi:[0,1]
    v_pk_fma_f16 v176, v172, v116, v144 op_sel:[1,1,0] op_sel_hi:[1,0,1] neg_lo:[0,1,0]
    v_pk_fma_f16 v177, v173, v117, v145 op_sel:[1,1,0] op_sel_hi:[1,0,1] neg_lo:[0,1,0]
    v_mfma_f32_16x16x32_f16 v[200:203], v[172:175], v[152:155], v[200:203]
    v_pk_fma_f16 v178, v174, v118, v146 op_sel:[1,1,0] op_sel_hi:[1,0,1] neg_lo:[0,1,0]
    v_pk_fma_f16 v179, v175, v119, v147 op_sel:[1,1,0] op_sel_hi:[1,0,1] neg_lo:[0,1,0]
    s_waitcnt lgkmcnt(0)
    v_pk_mul_f16 v144, v120, v124 op_sel:[0,0] op_sel_hi:[0,1]
    v_pk_mul_f16 v145, v121, v125 op_sel:[0,0] op_sel_hi:[0,1]
    v_mfma_f32_16x16x32_f16 v[204:207], v[176:179], v[148:151], v[204:207]
    ds_read_b128 v[4:7], v27 offset:384
    ds_read_b128 v[100:103], v33 offset:4736
    v_pk_mul_f16 v146, v122, v126 op_sel:[0,0] op_sel_hi:[0,1]
    v_pk_mul_f16 v147, v123, v127 op_sel:[0,0] op_sel_hi:[0,1]
    v_pk_fma_f16 v156, v120, v124, v144 op_sel:[1,1,0] op_sel_hi:[1,0,1] neg_lo:[0,1,0]
    v_pk_fma_f16 v157, v121, v125, v145 op_sel:[1,1,0] op_sel_hi:[1,0,1] neg_lo:[0,1,0]
    v_mfma_f32_16x16x32_f16 v[208:211], v[176:179], v[152:155], v[208:211]
    ds_read_b128 v[104:107], v48 offset:17792
    ds_read_b128 v[108:111], v27 offset:9088
    v_pk_fma_f16 v158, v122, v126, v146 op_sel:[1,1,0] op_sel_hi:[1,0,1] neg_lo:[0,1,0]
    v_pk_fma_f16 v159, v123, v127, v147 op_sel:[1,1,0] op_sel_hi:[1,0,1] neg_lo:[0,1,0]
    v_pk_mul_f16 v144, v156, v128 op_sel:[0,0] op_sel_hi:[0,1]
    v_pk_mul_f16 v145, v157, v129 op_sel:[0,0] op_sel_hi:[0,1]
    v_pk_mul_f16 v146, v158, v130 op_sel:[0,0] op_sel_hi:[0,1]
    v_pk_mul_f16 v147, v159, v131 op_sel:[0,0] op_sel_hi:[0,1]
    v_pk_fma_f16 v160, v156, v128, v144 op_sel:[1,1,0] op_sel_hi:[1,0,1] neg_lo:[0,1,0]
    v_pk_fma_f16 v161, v157, v129, v145 op_sel:[1,1,0] op_sel_hi:[1,0,1] neg_lo:[0,1,0]
    v_pk_fma_f16 v162, v158, v130, v146 op_sel:[1,1,0] op_sel_hi:[1,0,1] neg_lo:[0,1,0]
    v_pk_fma_f16 v163, v159, v131, v147 op_sel:[1,1,0] op_sel_hi:[1,0,1] neg_lo:[0,1,0]
    v_pk_mul_f16 v144, v132, v136 op_sel:[0,0] op_sel_hi:[0,1]
    v_pk_mul_f16 v145, v133, v137 op_sel:[0,0] op_sel_hi:[0,1]
    v_pk_mul_f16 v146, v134, v138 op_sel:[0,0] op_sel_hi:[0,1]
    v_pk_mul_f16 v147, v135, v139 op_sel:[0,0] op_sel_hi:[0,1]
    v_pk_fma_f16 v164, v132, v136, v144 op_sel:[1,1,0] op_sel_hi:[1,0,1] neg_lo:[0,1,0]
    v_pk_fma_f16 v165, v133, v137, v145 op_sel:[1,1,0] op_sel_hi:[1,0,1] neg_lo:[0,1,0]
    v_pk_fma_f16 v166, v134, v138, v146 op_sel:[1,1,0] op_sel_hi:[1,0,1] neg_lo:[0,1,0]
    v_pk_fma_f16 v167, v135, v139, v147 op_sel:[1,1,0] op_sel_hi:[1,0,1] neg_lo:[0,1,0]
    v_pk_mul_f16 v144, v164, v140 op_sel:[0,0] op_sel_hi:[0,1]
    v_pk_mul_f16 v145, v165, v141 op_sel:[0,0] op_sel_hi:[0,1]
    v_mfma_f32_16x16x32_f16 v[180:183], v[164:167], v[156:159], v[180:183]
    ds_read_b128 v[112:115], v33 offset:13440
    ds_read_b128 v[116:119], v48 offset:18880
    v_pk_mul_f16 v146, v166, v142 op_sel:[0,0] op_sel_hi:[0,1]
    v_pk_mul_f16 v147, v167, v143 op_sel:[0,0] op_sel_hi:[0,1]
    v_pk_fma_f16 v168, v164, v140, v144 op_sel:[1,1,0] op_sel_hi:[1,0,1] neg_lo:[0,1,0]
    v_pk_fma_f16 v169, v165, v141, v145 op_sel:[1,1,0] op_sel_hi:[1,0,1] neg_lo:[0,1,0]
    v_mfma_f32_16x16x32_f16 v[184:187], v[164:167], v[160:163], v[184:187]
    v_pk_fma_f16 v170, v166, v142, v146 op_sel:[1,1,0] op_sel_hi:[1,0,1] neg_lo:[0,1,0]
    v_pk_fma_f16 v171, v167, v143, v147 op_sel:[1,1,0] op_sel_hi:[1,0,1] neg_lo:[0,1,0]
    v_pk_mul_f16 v144, v168, v140 op_sel:[0,0] op_sel_hi:[0,1]
    v_pk_mul_f16 v145, v169, v141 op_sel:[0,0] op_sel_hi:[0,1]
    v_mfma_f32_16x16x32_f16 v[188:191], v[168:171], v[156:159], v[188:191]
    v_pk_mul_f16 v146, v170, v142 op_sel:[0,0] op_sel_hi:[0,1]
    v_pk_mul_f16 v147, v171, v143 op_sel:[0,0] op_sel_hi:[0,1]
    v_pk_fma_f16 v172, v168, v140, v144 op_sel:[1,1,0] op_sel_hi:[1,0,1] neg_lo:[0,1,0]
    v_pk_fma_f16 v173, v169, v141, v145 op_sel:[1,1,0] op_sel_hi:[1,0,1] neg_lo:[0,1,0]
    v_mfma_f32_16x16x32_f16 v[192:195], v[168:171], v[160:163], v[192:195]
    v_pk_fma_f16 v174, v170, v142, v146 op_sel:[1,1,0] op_sel_hi:[1,0,1] neg_lo:[0,1,0]
    v_pk_fma_f16 v175, v171, v143, v147 op_sel:[1,1,0] op_sel_hi:[1,0,1] neg_lo:[0,1,0]
    v_pk_mul_f16 v144, v172, v140 op_sel:[0,0] op_sel_hi:[0,1]
    v_pk_mul_f16 v145, v173, v141 op_sel:[0,0] op_sel_hi:[0,1]
    v_mfma_f32_16x16x32_f16 v[196:199], v[172:175], v[156:159], v[196:199]
    v_pk_mul_f16 v146, v174, v142 op_sel:[0,0] op_sel_hi:[0,1]
    v_pk_mul_f16 v147, v175, v143 op_sel:[0,0] op_sel_hi:[0,1]
    v_pk_fma_f16 v176, v172, v140, v144 op_sel:[1,1,0] op_sel_hi:[1,0,1] neg_lo:[0,1,0]
    v_pk_fma_f16 v177, v173, v141, v145 op_sel:[1,1,0] op_sel_hi:[1,0,1] neg_lo:[0,1,0]
    v_mfma_f32_16x16x32_f16 v[200:203], v[172:175], v[160:163], v[200:203]
    v_pk_fma_f16 v178, v174, v142, v146 op_sel:[1,1,0] op_sel_hi:[1,0,1] neg_lo:[0,1,0]
    v_pk_fma_f16 v179, v175, v143, v147 op_sel:[1,1,0] op_sel_hi:[1,0,1] neg_lo:[0,1,0]
    s_waitcnt lgkmcnt(0)
    v_pk_mul_f16 v144, v4, v100 op_sel:[0,0] op_sel_hi:[0,1]
    v_pk_mul_f16 v145, v5, v101 op_sel:[0,0] op_sel_hi:[0,1]
    v_mfma_f32_16x16x32_f16 v[204:207], v[176:179], v[156:159], v[204:207]
    ds_read_b128 v[120:123], v27 offset:448
    ds_read_b128 v[124:127], v33 offset:4800
    v_pk_mul_f16 v146, v6, v102 op_sel:[0,0] op_sel_hi:[0,1]
    v_pk_mul_f16 v147, v7, v103 op_sel:[0,0] op_sel_hi:[0,1]
    v_pk_fma_f16 v148, v4, v100, v144 op_sel:[1,1,0] op_sel_hi:[1,0,1] neg_lo:[0,1,0]
    v_pk_fma_f16 v149, v5, v101, v145 op_sel:[1,1,0] op_sel_hi:[1,0,1] neg_lo:[0,1,0]
    v_mfma_f32_16x16x32_f16 v[208:211], v[176:179], v[160:163], v[208:211]
    ds_read_b128 v[128:131], v48 offset:17856
    ds_read_b128 v[132:135], v27 offset:9152
    v_pk_fma_f16 v150, v6, v102, v146 op_sel:[1,1,0] op_sel_hi:[1,0,1] neg_lo:[0,1,0]
    v_pk_fma_f16 v151, v7, v103, v147 op_sel:[1,1,0] op_sel_hi:[1,0,1] neg_lo:[0,1,0]
    v_pk_mul_f16 v144, v148, v104 op_sel:[0,0] op_sel_hi:[0,1]
    v_pk_mul_f16 v145, v149, v105 op_sel:[0,0] op_sel_hi:[0,1]
    v_pk_mul_f16 v146, v150, v106 op_sel:[0,0] op_sel_hi:[0,1]
    v_pk_mul_f16 v147, v151, v107 op_sel:[0,0] op_sel_hi:[0,1]
    v_pk_fma_f16 v152, v148, v104, v144 op_sel:[1,1,0] op_sel_hi:[1,0,1] neg_lo:[0,1,0]
    v_pk_fma_f16 v153, v149, v105, v145 op_sel:[1,1,0] op_sel_hi:[1,0,1] neg_lo:[0,1,0]
    v_pk_fma_f16 v154, v150, v106, v146 op_sel:[1,1,0] op_sel_hi:[1,0,1] neg_lo:[0,1,0]
    v_pk_fma_f16 v155, v151, v107, v147 op_sel:[1,1,0] op_sel_hi:[1,0,1] neg_lo:[0,1,0]
    v_pk_mul_f16 v144, v108, v112 op_sel:[0,0] op_sel_hi:[0,1]
    v_pk_mul_f16 v145, v109, v113 op_sel:[0,0] op_sel_hi:[0,1]
    v_pk_mul_f16 v146, v110, v114 op_sel:[0,0] op_sel_hi:[0,1]
    v_pk_mul_f16 v147, v111, v115 op_sel:[0,0] op_sel_hi:[0,1]
    v_pk_fma_f16 v164, v108, v112, v144 op_sel:[1,1,0] op_sel_hi:[1,0,1] neg_lo:[0,1,0]
    v_pk_fma_f16 v165, v109, v113, v145 op_sel:[1,1,0] op_sel_hi:[1,0,1] neg_lo:[0,1,0]
    v_pk_fma_f16 v166, v110, v114, v146 op_sel:[1,1,0] op_sel_hi:[1,0,1] neg_lo:[0,1,0]
    v_pk_fma_f16 v167, v111, v115, v147 op_sel:[1,1,0] op_sel_hi:[1,0,1] neg_lo:[0,1,0]
    v_pk_mul_f16 v144, v164, v116 op_sel:[0,0] op_sel_hi:[0,1]
    v_pk_mul_f16 v145, v165, v117 op_sel:[0,0] op_sel_hi:[0,1]
    v_mfma_f32_16x16x32_f16 v[180:183], v[164:167], v[148:151], v[180:183]
    ds_read_b128 v[136:139], v33 offset:13504
    ds_read_b128 v[140:143], v48 offset:18944
    v_pk_mul_f16 v146, v166, v118 op_sel:[0,0] op_sel_hi:[0,1]
    v_pk_mul_f16 v147, v167, v119 op_sel:[0,0] op_sel_hi:[0,1]
    v_pk_fma_f16 v168, v164, v116, v144 op_sel:[1,1,0] op_sel_hi:[1,0,1] neg_lo:[0,1,0]
    v_pk_fma_f16 v169, v165, v117, v145 op_sel:[1,1,0] op_sel_hi:[1,0,1] neg_lo:[0,1,0]
    v_mfma_f32_16x16x32_f16 v[184:187], v[164:167], v[152:155], v[184:187]
    buffer_load_dword v72, v73, s[44:47], 0 offen sc1
    buffer_load_dwordx4 v[76:79], v65, s[40:43], 0 offen offset:0 sc1
    v_pk_fma_f16 v170, v166, v118, v146 op_sel:[1,1,0] op_sel_hi:[1,0,1] neg_lo:[0,1,0]
    v_pk_fma_f16 v171, v167, v119, v147 op_sel:[1,1,0] op_sel_hi:[1,0,1] neg_lo:[0,1,0]
    v_pk_mul_f16 v144, v168, v116 op_sel:[0,0] op_sel_hi:[0,1]
    v_pk_mul_f16 v145, v169, v117 op_sel:[0,0] op_sel_hi:[0,1]
    v_mfma_f32_16x16x32_f16 v[188:191], v[168:171], v[148:151], v[188:191]
    buffer_load_dwordx4 v[80:83], v65, s[40:43], 0 offen offset:16 sc1
    buffer_load_dwordx4 v[84:87], v65, s[40:43], 0 offen offset:32 sc1
    v_pk_mul_f16 v146, v170, v118 op_sel:[0,0] op_sel_hi:[0,1]
    v_pk_mul_f16 v147, v171, v119 op_sel:[0,0] op_sel_hi:[0,1]
    v_pk_fma_f16 v172, v168, v116, v144 op_sel:[1,1,0] op_sel_hi:[1,0,1] neg_lo:[0,1,0]
    v_pk_fma_f16 v173, v169, v117, v145 op_sel:[1,1,0] op_sel_hi:[1,0,1] neg_lo:[0,1,0]
    v_mfma_f32_16x16x32_f16 v[192:195], v[168:171], v[152:155], v[192:195]
    buffer_load_dwordx4 v[88:91], v65, s[40:43], 0 offen offset:48 sc1
    v_pk_fma_f16 v174, v170, v118, v146 op_sel:[1,1,0] op_sel_hi:[1,0,1] neg_lo:[0,1,0]
    v_pk_fma_f16 v175, v171, v119, v147 op_sel:[1,1,0] op_sel_hi:[1,0,1] neg_lo:[0,1,0]
    v_pk_mul_f16 v144, v172, v116 op_sel:[0,0] op_sel_hi:[0,1]
    v_pk_mul_f16 v145, v173, v117 op_sel:[0,0] op_sel_hi:[0,1]
    v_mfma_f32_16x16x32_f16 v[196:199], v[172:175], v[148:151], v[196:199]
    v_pk_mul_f16 v146, v174, v118 op_sel:[0,0] op_sel_hi:[0,1]
    v_pk_mul_f16 v147, v175, v119 op_sel:[0,0] op_sel_hi:[0,1]
    v_pk_fma_f16 v176, v172, v116, v144 op_sel:[1,1,0] op_sel_hi:[1,0,1] neg_lo:[0,1,0]
    v_pk_fma_f16 v177, v173, v117, v145 op_sel:[1,1,0] op_sel_hi:[1,0,1] neg_lo:[0,1,0]
    v_mfma_f32_16x16x32_f16 v[200:203], v[172:175], v[152:155], v[200:203]
    v_pk_fma_f16 v178, v174, v118, v146 op_sel:[1,1,0] op_sel_hi:[1,0,1] neg_lo:[0,1,0]
    v_pk_fma_f16 v179, v175, v119, v147 op_sel:[1,1,0] op_sel_hi:[1,0,1] neg_lo:[0,1,0]
    s_waitcnt lgkmcnt(0)
    v_pk_mul_f16 v144, v120, v124 op_sel:[0,0] op_sel_hi:[0,1]
    v_pk_mul_f16 v145, v121, v125 op_sel:[0,0] op_sel_hi:[0,1]
    v_mfma_f32_16x16x32_f16 v[204:207], v[176:179], v[148:151], v[204:207]
    s_add_u32 s100, s14, 0
    s_add_u32 m0, s81, 0
    v_pk_mul_f16 v146, v122, v126 op_sel:[0,0] op_sel_hi:[0,1]
    v_pk_mul_f16 v147, v123, v127 op_sel:[0,0] op_sel_hi:[0,1]
    v_pk_fma_f16 v156, v120, v124, v144 op_sel:[1,1,0] op_sel_hi:[1,0,1] neg_lo:[0,1,0]
    v_pk_fma_f16 v157, v121, v125, v145 op_sel:[1,1,0] op_sel_hi:[1,0,1] neg_lo:[0,1,0]
    v_mfma_f32_16x16x32_f16 v[208:211], v[176:179], v[152:155], v[208:211]
    buffer_load_dwordx4 v26, s[48:51], s100 offen lds
    s_add_u32 m0, s81, 4096
    v_pk_fma_f16 v158, v122, v126, v146 op_sel:[1,1,0] op_sel_hi:[1,0,1] neg_lo:[0,1,0]
    v_pk_fma_f16 v159, v123, v127, v147 op_sel:[1,1,0] op_sel_hi:[1,0,1] neg_lo:[0,1,0]
    v_pk_mul_f16 v144, v156, v128 op_sel:[0,0] op_sel_hi:[0,1]
    v_pk_mul_f16 v145, v157, v129 op_sel:[0,0] op_sel_hi:[0,1]
    v_pk_mul_f16 v146, v158, v130 op_sel:[0,0] op_sel_hi:[0,1]
    v_pk_mul_f16 v147, v159, v131 op_sel:[0,0] op_sel_hi:[0,1]
    v_pk_fma_f16 v160, v156, v128, v144 op_sel:[1,1,0] op_sel_hi:[1,0,1] neg_lo:[0,1,0]
    v_pk_fma_f16 v161, v157, v129, v145 op_sel:[1,1,0] op_sel_hi:[1,0,1] neg_lo:[0,1,0]
    v_pk_fma_f16 v162, v158, v130, v146 op_sel:[1,1,0] op_sel_hi:[1,0,1] neg_lo:[0,1,0]
    v_pk_fma_f16 v163, v159, v131, v147 op_sel:[1,1,0] op_sel_hi:[1,0,1] neg_lo:[0,1,0]
    v_pk_mul_f16 v144, v132, v136 op_sel:[0,0] op_sel_hi:[0,1]
    v_pk_mul_f16 v145, v133, v137 op_sel:[0,0] op_sel_hi:[0,1]
    v_pk_mul_f16 v146, v134, v138 op_sel:[0,0] op_sel_hi:[0,1]
    v_pk_mul_f16 v147, v135, v139 op_sel:[0,0] op_sel_hi:[0,1]
    v_pk_fma_f16 v164, v132, v136, v144 op_sel:[1,1,0] op_sel_hi:[1,0,1] neg_lo:[0,1,0]
    v_pk_fma_f16 v165, v133, v137, v145 op_sel:[1,1,0] op_sel_hi:[1,0,1] neg_lo:[0,1,0]
    v_pk_fma_f16 v166, v134, v138, v146 op_sel:[1,1,0] op_sel_hi:[1,0,1] neg_lo:[0,1,0]
    v_pk_fma_f16 v167, v135, v139, v147 op_sel:[1,1,0] op_sel_hi:[1,0,1] neg_lo:[0,1,0]
    v_pk_mul_f16 v144, v164, v140 op_sel:[0,0] op_sel_hi:[0,1]
    v_pk_mul_f16 v145, v165, v141 op_sel:[0,0] op_sel_hi:[0,1]
    v_mfma_f32_16x16x32_f16 v[180:183], v[164:167], v[156:159], v[180:183]
    buffer_load_dwordx4 v26, s[52:55], s100 offen lds
    v_pk_mul_f16 v146, v166, v142 op_sel:[0,0] op_sel_hi:[0,1]
    v_pk_mul_f16 v147, v167, v143 op_sel:[0,0] op_sel_hi:[0,1]
    v_pk_fma_f16 v168, v164, v140, v144 op_sel:[1,1,0] op_sel_hi:[1,0,1] neg_lo:[0,1,0]
    v_pk_fma_f16 v169, v165, v141, v145 op_sel:[1,1,0] op_sel_hi:[1,0,1] neg_lo:[0,1,0]
    v_mfma_f32_16x16x32_f16 v[184:187], v[164:167], v[160:163], v[184:187]
    v_pk_fma_f16 v170, v166, v142, v146 op_sel:[1,1,0] op_sel_hi:[1,0,1] neg_lo:[0,1,0]
    v_pk_fma_f16 v171, v167, v143, v147 op_sel:[1,1,0] op_sel_hi:[1,0,1] neg_lo:[0,1,0]
    v_pk_mul_f16 v144, v168, v140 op_sel:[0,0] op_sel_hi:[0,1]
    v_pk_mul_f16 v145, v169, v141 op_sel:[0,0] op_sel_hi:[0,1]
    v_mfma_f32_16x16x32_f16 v[188:191], v[168:171], v[156:159], v[188:191]
    v_pk_mul_f16 v146, v170, v142 op_sel:[0,0] op_sel_hi:[0,1]
    v_pk_mul_f16 v147, v171, v143 op_sel:[0,0] op_sel_hi:[0,1]
    v_pk_fma_f16 v172, v168, v140, v144 op_sel:[1,1,0] op_sel_hi:[1,0,1] neg_lo:[0,1,0]
    v_pk_fma_f16 v173, v169, v141, v145 op_sel:[1,1,0] op_sel_hi:[1,0,1] neg_lo:[0,1,0]
    v_mfma_f32_16x16x32_f16 v[192:195], v[168:171], v[160:163], v[192:195]
    v_pk_fma_f16 v174, v170, v142, v146 op_sel:[1,1,0] op_sel_hi:[1,0,1] neg_lo:[0,1,0]
    v_pk_fma_f16 v175, v171, v143, v147 op_sel:[1,1,0] op_sel_hi:[1,0,1] neg_lo:[0,1,0]
    v_pk_mul_f16 v144, v172, v140 op_sel:[0,0] op_sel_hi:[0,1]
    v_pk_mul_f16 v145, v173, v141 op_sel:[0,0] op_sel_hi:[0,1]
    v_mfma_f32_16x16x32_f16 v[196:199], v[172:175], v[156:159], v[196:199]
    v_pk_mul_f16 v146, v174, v142 op_sel:[0,0] op_sel_hi:[0,1]
    v_pk_mul_f16 v147, v175, v143 op_sel:[0,0] op_sel_hi:[0,1]
    v_pk_fma_f16 v176, v172, v140, v144 op_sel:[1,1,0] op_sel_hi:[1,0,1] neg_lo:[0,1,0]
    v_pk_fma_f16 v177, v173, v141, v145 op_sel:[1,1,0] op_sel_hi:[1,0,1] neg_lo:[0,1,0]
    v_mfma_f32_16x16x32_f16 v[200:203], v[172:175], v[160:163], v[200:203]
    v_pk_fma_f16 v178, v174, v142, v146 op_sel:[1,1,0] op_sel_hi:[1,0,1] neg_lo:[0,1,0]
    v_pk_fma_f16 v179, v175, v143, v147 op_sel:[1,1,0] op_sel_hi:[1,0,1] neg_lo:[0,1,0]
    s_nop 1
    v_mfma_f32_16x16x32_f16 v[204:207], v[176:179], v[156:159], v[204:207]
    v_mfma_f32_16x16x32_f16 v[208:211], v[176:179], v[160:163], v[208:211]
    v_mov_b32 v2, s101
    s_and_b32 s74, s64, 1
    s_cmp_lg_u32 s74, 0
    s_cbranch_scc1 Lp1_16
    v_pk_mul_f32 v[196:197], v[196:197], v[2:3] op_sel_hi:[1,0]
    v_pk_mul_f32 v[198:199], v[198:199], v[2:3] op_sel_hi:[1,0]
    ds_write_b128 v50, v[196:199] offset:0
    v_pk_mul_f32 v[200:201], v[200:201], v[2:3] op_sel_hi:[1,0]
    v_pk_mul_f32 v[202:203], v[202:203], v[2:3] op_sel_hi:[1,0]
    ds_write_b128 v50, v[200:203] offset:1024
    v_pk_mul_f32 v[204:205], v[204:205], v[2:3] op_sel_hi:[1,0]
    v_pk_mul_f32 v[206:207], v[206:207], v[2:3] op_sel_hi:[1,0]
    ds_write_b128 v50, v[204:207] offset:2048
    v_pk_mul_f32 v[208:209], v[208:209], v[2:3] op_sel_hi:[1,0]
    v_pk_mul_f32 v[210:211], v[210:211], v[2:3] op_sel_hi:[1,0]
    ds_write_b128 v50, v[208:211] offset:3072
    s_mov_b64 s[84:85], exec
    s_mov_b64 exec, 1
    ds_write_b32 v52, v46
    s_mov_b64 exec, s[84:85]
    s_waitcnt lgkmcnt(0)
    s_barrier
    ds_read_b128 v[4:7], v51 offset:0
    ds_read_b128 v[100:103], v51 offset:1024
    ds_read_b128 v[104:107], v51 offset:2048
    ds_read_b128 v[108:111], v51 offset:3072
    ds_read_b32 v144, v53
    s_waitcnt lgkmcnt(4)
    v_pk_fma_f32 v[180:181], v[180:181], v[2:3], v[4:5] op_sel_hi:[1,0,1]
    v_pk_fma_f32 v[182:183], v[182:183], v[2:3], v[6:7] op_sel_hi:[1,0,1]
    ds_write_b32 v54, v180 offset:0
    ds_write_b32 v54, v181 offset:144
    ds_write_b32 v54, v182 offset:288
    ds_write_b32 v54, v183 offset:432
    s_waitcnt lgkmcnt(7)
    v_pk_fma_f32 v[184:185], v[184:185], v[2:3], v[100:101] op_sel_hi:[1,0,1]
    v_pk_fma_f32 v[186:187], v[186:187], v[2:3], v[102:103] op_sel_hi:[1,0,1]
    ds_write_b32 v54, v184 offset:72
    ds_write_b32 v54, v185 offset:216
    ds_write_b32 v54, v186 offset:360
    ds_write_b32 v54, v187 offset:504
    s_waitcnt lgkmcnt(10)
    v_pk_fma_f32 v[188:189], v[188:189], v[2:3], v[104:105] op_sel_hi:[1,0,1]
    v_pk_fma_f32 v[190:191], v[190:191], v[2:3], v[106:107] op_sel_hi:[1,0,1]
    ds_write_b32 v54, v188 offset:2304
    ds_write_b32 v54, v189 offset:2448
    ds_write_b32 v54, v190 offset:2592
    ds_write_b32 v54, v191 offset:2736
    s_waitcnt lgkmcnt(13)
    v_pk_fma_f32 v[192:193], v[192:193], v[2:3], v[108:109] op_sel_hi:[1,0,1]
    v_pk_fma_f32 v[194:195], v[194:195], v[2:3], v[110:111] op_sel_hi:[1,0,1]
    ds_write_b32 v54, v192 offset:2376
    ds_write_b32 v54, v193 offset:2520
    ds_write_b32 v54, v194 offset:2664
    ds_write_b32 v54, v195 offset:2808
    s_waitcnt lgkmcnt(14)
    v_add_f32 v46, v46, v144
    v_mov_b32 v47, 0
    s_mov_b64 s[84:85], exec
    s_mov_b64 exec, 1
    ds_write_b32 v55, v46 offset:9216
    ds_write_b32 v55, v47 offset:9280
    s_mov_b64 exec, s[84:85]
    s_branch Lpd_17
Lp1_16:
    s_nop 7
    v_pk_mul_f32 v[180:181], v[180:181], v[2:3] op_sel_hi:[1,0]
    v_pk_mul_f32 v[182:183], v[182:183], v[2:3] op_sel_hi:[1,0]
    ds_write_b128 v50, v[180:183] offset:0
    v_pk_mul_f32 v[184:185], v[184:185], v[2:3] op_sel_hi:[1,0]
    v_pk_mul_f32 v[186:187], v[186:187], v[2:3] op_sel_hi:[1,0]
    ds_write_b128 v50, v[184:187] offset:1024
    v_pk_mul_f32 v[188:189], v[188:189], v[2:3] op_sel_hi:[1,0]
    v_pk_mul_f32 v[190:191], v[190:191], v[2:3] op_sel_hi:[1,0]
    ds_write_b128 v50, v[188:191] offset:2048
    v_pk_mul_f32 v[192:193], v[192:193], v[2:3] op_sel_hi:[1,0]
    v_pk_mul_f32 v[194:195], v[194:195], v[2:3] op_sel_hi:[1,0]
    ds_write_b128 v50, v[192:195] offset:3072
    s_mov_b64 s[84:85], exec
    s_mov_b64 exec, 1
    ds_write_b32 v52, v46
    s_mov_b64 exec, s[84:85]
    s_waitcnt lgkmcnt(0)
    s_barrier
    ds_read_b128 v[4:7], v51 offset:0
    ds_read_b128 v[100:103], v51 offset:1024
    ds_read_b128 v[104:107], v51 offset:2048
    ds_read_b128 v[108:111], v51 offset:3072
    ds_read_b32 v144, v53
    s_waitcnt lgkmcnt(4)
    v_pk_fma_f32 v[196:197], v[196:197], v[2:3], v[4:5] op_sel_hi:[1,0,1]
    v_pk_fma_f32 v[198:199], v[198:199], v[2:3], v[6:7] op_sel_hi:[1,0,1]
    ds_write_b32 v54, v196 offset:0
    ds_write_b32 v54, v197 offset:144
    ds_write_b32 v54, v198 offset:288
    ds_write_b32 v54, v199 offset:432
    s_waitcnt lgkmcnt(7)
    v_pk_fma_f32 v[200:201], v[200:201], v[2:3], v[100:101] op_sel_hi:[1,0,1]
    v_pk_fma_f32 v[202:203], v[202:203], v[2:3], v[102:103] op_sel_hi:[1,0,1]
    ds_write_b32 v54, v200 offset:72
    ds_write_b32 v54, v201 offset:216
    ds_write_b32 v54, v202 offset:360
    ds_write_b32 v54, v203 offset:504
    s_waitcnt lgkmcnt(10)
    v_pk_fma_f32 v[204:205], v[204:205], v[2:3], v[104:105] op_sel_hi:[1,0,1]
    v_pk_fma_f32 v[206:207], v[206:207], v[2:3], v[106:107] op_sel_hi:[1,0,1]
    ds_write_b32 v54, v204 offset:2304
    ds_write_b32 v54, v205 offset:2448
    ds_write_b32 v54, v206 offset:2592
    ds_write_b32 v54, v207 offset:2736
    s_waitcnt lgkmcnt(13)
    v_pk_fma_f32 v[208:209], v[208:209], v[2:3], v[108:109] op_sel_hi:[1,0,1]
    v_pk_fma_f32 v[210:211], v[210:211], v[2:3], v[110:111] op_sel_hi:[1,0,1]
    ds_write_b32 v54, v208 offset:2376
    ds_write_b32 v54, v209 offset:2520
    ds_write_b32 v54, v210 offset:2664
    ds_write_b32 v54, v211 offset:2808
    s_waitcnt lgkmcnt(14)
    v_add_f32 v46, v46, v144
    v_mov_b32 v47, 0
    s_mov_b64 s[84:85], exec
    s_mov_b64 exec, 1
    ds_write_b32 v55, v46 offset:9216
    ds_write_b32 v55, v47 offset:9280
    s_mov_b64 exec, s[84:85]
Lpd_17:
    s_add_u32 s100, s14, 57344
    s_add_u32 m0, s81, 8192
    s_nop 0
    buffer_load_dwordx4 v26, s[48:51], s100 offen lds
    s_add_u32 m0, s81, 12288
    s_nop 0
    buffer_load_dwordx4 v26, s[52:55], s100 offen lds
    s_add_u32 s100, s14, 114688
    s_add_u32 m0, s81, 16384
    s_nop 0
    buffer_load_dwordx4 v26, s[48:51], s100 offen lds
    s_add_u32 m0, s81, 20480
    s_nop 0
    buffer_load_dwordx4 v26, s[52:55], s100 offen lds
    s_waitcnt lgkmcnt(0)
    s_barrier
    v_mov_b32 v4, 0
    v_mov_b32 v5, 0
    v_mov_b32 v6, 0
    v_mov_b32 v7, 0
    v_lshrrev_b32 v2, 2, v0
    v_mul_u32_u24 v2, 4160, v2
    v_and_b32 v3, 3, v0
    v_lshl_add_u32 v2, v3, 4, v2
    v_cmp_gt_u32 vcc, 32, v0
    s_nop 0
    s_and_saveexec_b64 s[84:85], vcc
    s_cbranch_execz Lzc_18
    ds_write_b128 v2, v[4:7] offset:4096
Lzc_18:
    s_mov_b64 exec, s[84:85]
    v_lshrrev_b32 v2, 6, v0
    v_mul_u32_u24 v2, 5120, v2
    v_lshl_add_u32 v2, v1, 4, v2
    v_cmp_gt_u32 vcc, 128, v0
    s_nop 0
    s_and_saveexec_b64 s[84:85], vcc
    s_cbranch_execz Lzu_19
    ds_write_b128 v2, v[4:7] offset:33280
Lzu_19:
    s_mov_b64 exec, s[84:85]
    ds_read_b32 v100, v34 offset:0
    ds_read_b32 v101, v35 offset:0
    ds_read_b32 v102, v36 offset:0
    ds_read_b32 v103, v37 offset:0
    ds_read_b32 v104, v38 offset:0
    ds_read_b32 v105, v39 offset:0
    ds_read_b32 v106, v40 offset:0
    ds_read_b32 v107, v41 offset:0
    ds_read_b32 v108, v42 offset:0
    ds_read_b32 v109, v43 offset:0
    ds_read_b32 v110, v44 offset:0
    ds_read_b32 v111, v34 offset:9344
    ds_read_b32 v112, v35 offset:9344
    ds_read_b32 v113, v36 offset:9344
    ds_read_b32 v114, v37 offset:9344
    ds_read_b32 v115, v38 offset:9344
    ds_read_b32 v116, v39 offset:9344
    ds_read_b32 v117, v40 offset:9344
    ds_read_b32 v118, v41 offset:9344
    ds_read_b32 v119, v42 offset:9344
    ds_read_b32 v120, v43 offset:9344
    ds_read_b32 v121, v44 offset:9344
    s_add_u32 s100, s14, 172032
    s_add_u32 m0, s81, 24576
    s_nop 0
    buffer_load_dwordx4 v26, s[48:51], s100 offen lds
    s_add_u32 m0, s81, 28672
    s_nop 0
    buffer_load_dwordx4 v26, s[52:55], s100 offen lds
    v_lshlrev_b32 v2, 4, v0
    s_waitcnt lgkmcnt(11)
    v_cvt_pk_bf16_f32 v124, v103, v104
    v_cvt_pk_bf16_f32 v125, v105, v106
    v_cvt_pk_bf16_f32 v126, v107, v108
    v_cvt_pk_bf16_f32 v127, v109, v110
    ds_write_b128 v2, v[124:127] offset:0
    v_cvt_pk_bf16_f32 v128, v102, v103
    v_cvt_pk_bf16_f32 v129, v104, v105
    v_cvt_pk_bf16_f32 v130, v106, v107
    v_cvt_pk_bf16_f32 v131, v108, v109
    ds_write_b128 v2, v[128:131] offset:4160
    v_cvt_pk_bf16_f32 v132, v101, v102
    v_cvt_pk_bf16_f32 v133, v103, v104
    v_cvt_pk_bf16_f32 v134, v105, v106
    v_cvt_pk_bf16_f32 v135, v107, v108
    ds_write_b128 v2, v[132:135] offset:8320
    v_cvt_pk_bf16_f32 v136, v100, v101
    v_cvt_pk_bf16_f32 v137, v102, v103
    v_cvt_pk_bf16_f32 v138, v104, v105
    v_cvt_pk_bf16_f32 v139, v106, v107
    ds_write_b128 v2, v[136:139] offset:12480
    s_waitcnt lgkmcnt(4)
    v_cvt_pk_bf16_f32 v140, v114, v115
    v_cvt_pk_bf16_f32 v141, v116, v117
    v_cvt_pk_bf16_f32 v142, v118, v119
    v_cvt_pk_bf16_f32 v143, v120, v121
    ds_write_b128 v2, v[140:143] offset:16640
    v_cvt_pk_bf16_f32 v144, v113, v114
    v_cvt_pk_bf16_f32 v145, v115, v116
    v_cvt_pk_bf16_f32 v146, v117, v118
    v_cvt_pk_bf16_f32 v147, v119, v120
    ds_write_b128 v2, v[144:147] offset:20800
    v_cvt_pk_bf16_f32 v148, v112, v113
    v_cvt_pk_bf16_f32 v149, v114, v115
    v_cvt_pk_bf16_f32 v150, v116, v117
    v_cvt_pk_bf16_f32 v151, v118, v119
    ds_write_b128 v2, v[148:151] offset:24960
    v_cvt_pk_bf16_f32 v152, v111, v112
    v_cvt_pk_bf16_f32 v153, v113, v114
    v_cvt_pk_bf16_f32 v154, v115, v116
    v_cvt_pk_bf16_f32 v155, v117, v118
    ds_write_b128 v2, v[152:155] offset:29120
    s_add_u32 s100, s14, 229376
    s_add_u32 m0, s81, 32768
    s_nop 0
    buffer_load_dwordx4 v26, s[48:51], s100 offen lds
    s_add_u32 m0, s81, 36864
    s_nop 0
    buffer_load_dwordx4 v26, s[52:55], s100 offen lds
    s_waitcnt vmcnt(15)
    s_mov_b32 s69, 0x05040100
    s_mov_b32 s70, 0x07060302
    v_perm_b32 v92, v11, v10, s69
    v_perm_b32 v96, v11, v10, s70
    v_perm_b32 v93, v13, v12, s69
    v_perm_b32 v97, v13, v12, s70
    v_perm_b32 v94, v15, v14, s69
    v_perm_b32 v98, v15, v14, s70
    v_perm_b32 v95, v17, v16, s69
    v_perm_b32 v99, v17, v16, s70
    s_waitcnt vmcnt(10)
    s_mov_b32 s90, 0
Lsp_20:
    v_readfirstlane_b32 s65, v72
    s_nop 0
    s_cmp_eq_u32 s65, 0
    s_cbranch_scc1 Lspr_22
    v_min3_u32 v2, v77, v79, v81
    v_max3_u32 v3, v77, v79, v81
    v_min3_u32 v2, v2, v83, v85
    v_max3_u32 v3, v3, v83, v85
    v_min3_u32 v2, v2, v87, v89
    v_max3_u32 v3, v3, v87, v89
    v_min_u32 v2, v2, v91
    v_max_u32 v3, v3, v91
    v_xor_b32 v2, s65, v2
    v_xor_b32 v3, s65, v3
    v_or_b32 v2, v2, v3
    v_cmp_ne_u32 vcc, 0, v2
    s_cbranch_vccz Lspd_21
Lspr_22:
    s_sleep 2
    buffer_load_dword v72, v73, s[44:47], 0 offen sc1
    buffer_load_dwordx4 v[76:79], v65, s[40:43], 0 offen offset:0 sc1
    buffer_load_dwordx4 v[80:83], v65, s[40:43], 0 offen offset:16 sc1
    buffer_load_dwordx4 v[84:87], v65, s[40:43], 0 offen offset:32 sc1
    buffer_load_dwordx4 v[88:91], v65, s[40:43], 0 offen offset:48 sc1
    s_waitcnt vmcnt(0)
    s_add_u32 s90, s90, 1
    s_cmp_lt_u32 s90, 50000
    s_cbranch_scc1 Lsp_20
Lspd_21:
    v_lshlrev_b32 v116, 16, v76
    v_lshlrev_b32 v117, 16, v78
    v_lshlrev_b32 v118, 16, v80
    v_lshlrev_b32 v119, 16, v82
    v_lshlrev_b32 v120, 16, v84
    v_lshlrev_b32 v121, 16, v86
    v_lshlrev_b32 v122, 16, v88
    v_lshlrev_b32 v123, 16, v90
    v_lshlrev_b32 v100, 16, v92
    v_and_b32 v101, 0xffff0000, v92
    v_lshlrev_b32 v102, 16, v93
    v_and_b32 v103, 0xffff0000, v93
    v_lshlrev_b32 v104, 16, v94
    v_and_b32 v105, 0xffff0000, v94
    v_lshlrev_b32 v106, 16, v95
    v_and_b32 v107, 0xffff0000, v95
    v_bfe_u32 v3, v0, 4, 1
    v_lshlrev_b32 v108, 16, v96
    v_and_b32 v109, 0xffff0000, v96
    v_lshlrev_b32 v110, 16, v97
    v_and_b32 v111, 0xffff0000, v97
    v_lshlrev_b32 v112, 16, v98
    v_and_b32 v113, 0xffff0000, v98
    v_lshlrev_b32 v114, 16, v99
    v_and_b32 v115, 0xffff0000, v99
    v_pk_add_f32 v[100:101], v[100:101], v[116:117] neg_lo:[0,1] neg_hi:[0,1]
    v_pk_add_f32 v[102:103], v[102:103], v[118:119] neg_lo:[0,1] neg_hi:[0,1]
    v_pk_add_f32 v[104:105], v[104:105], v[120:121] neg_lo:[0,1] neg_hi:[0,1]
    v_pk_add_f32 v[106:107], v[106:107], v[122:123] neg_lo:[0,1] neg_hi:[0,1]
    v_and_b32 v124, 0xffff0000, v76
    v_and_b32 v125, 0xffff0000, v78
    v_and_b32 v126, 0xffff0000, v80
    v_and_b32 v127, 0xffff0000, v82
    v_and_b32 v128, 0xffff0000, v84
    v_and_b32 v129, 0xffff0000, v86
    v_and_b32 v130, 0xffff0000, v88
    v_and_b32 v131, 0xffff0000, v90
    v_lshlrev_b32 v3, 1, v3
    v_cvt_pk_bf16_f32 v101, v100, v101
    v_cvt_pk_bf16_f32 v103, v102, v103
    v_cvt_pk_bf16_f32 v105, v104, v105
    v_cvt_pk_bf16_f32 v107, v106, v107
    v_pk_add_f32 v[108:109], v[108:109], v[116:117] neg_lo:[0,1] neg_hi:[0,1]
    v_pk_add_f32 v[110:111], v[110:111], v[118:119] neg_lo:[0,1] neg_hi:[0,1]
    v_pk_add_f32 v[112:113], v[112:113], v[120:121] neg_lo:[0,1] neg_hi:[0,1]
    v_pk_add_f32 v[114:115], v[114:115], v[122:123] neg_lo:[0,1] neg_hi:[0,1]
    v_rcp_f32 v124, v124
    v_rcp_f32 v125, v125
    v_rcp_f32 v126, v126
    v_rcp_f32 v127, v127
    v_rcp_f32 v128, v128
    v_rcp_f32 v129, v129
    v_rcp_f32 v130, v130
    v_rcp_f32 v131, v131
    v_xor_b32 v2, v0, v3
    v_lshlrev_b32 v100, 16, v101
    v_lshlrev_b32 v102, 16, v103
    v_lshlrev_b32 v104, 16, v105
    v_lshlrev_b32 v106, 16, v107
    v_cvt_pk_bf16_f32 v109, v108, v109
    v_cvt_pk_bf16_f32 v111, v110, v111
    v_cvt_pk_bf16_f32 v113, v112, v113
    v_cvt_pk_bf16_f32 v115, v114, v115
    v_lshlrev_b32 v2, 4, v2
    v_and_b32 v101, 0xffff0000, v101
    v_and_b32 v103, 0xffff0000, v103
    v_and_b32 v105, 0xffff0000, v105
    v_and_b32 v107, 0xffff0000, v107
    v_lshlrev_b32 v108, 16, v109
    v_lshlrev_b32 v110, 16, v111
    v_lshlrev_b32 v112, 16, v113
    v_lshlrev_b32 v114, 16, v115
    ds_write_b128 v2, v[92:95] offset:43520
    v_pk_mul_f32 v[100:101], v[100:101], v[124:125]
    v_pk_mul_f32 v[102:103], v[102:103], v[126:127]
    v_pk_mul_f32 v[104:105], v[104:105], v[128:129]
    v_pk_mul_f32 v[106:107], v[106:107], v[130:131]
    v_and_b32 v109, 0xffff0000, v109
    v_and_b32 v111, 0xffff0000, v111
    v_and_b32 v113, 0xffff0000, v113
    v_and_b32 v115, 0xffff0000, v115
    ds_write_b128 v2, v[96:99] offset:47616
    v_cvt_pk_bf16_f32 v12, v100, v101
    v_cvt_pk_bf16_f32 v13, v102, v103
    v_cvt_pk_bf16_f32 v14, v104, v105
    v_cvt_pk_bf16_f32 v15, v106, v107
    v_pk_mul_f32 v[108:109], v[108:109], v[124:125]
    v_pk_mul_f32 v[110:111], v[110:111], v[126:127]
    v_pk_mul_f32 v[112:113], v[112:113], v[128:129]
    v_pk_mul_f32 v[114:115], v[114:115], v[130:131]
    ds_write_b128 v2, v[12:15] offset:34304
    v_cvt_pk_bf16_f32 v16, v108, v109
    v_cvt_pk_bf16_f32 v17, v110, v111
    v_cvt_pk_bf16_f32 v18, v112, v113
    v_cvt_pk_bf16_f32 v19, v114, v115
    ds_write_b128 v2, v[16:19] offset:39424
    s_waitcnt vmcnt(4)
    s_waitcnt lgkmcnt(0)
    s_barrier
    ds_read_b64_tr_b16 a[0:1], v28 offset:0
    ds_read_b64_tr_b16 a[2:3], v28 offset:2048
    ds_read_b64_tr_b16 a[4:5], v28 offset:4096
    ds_read_b64_tr_b16 a[6:7], v28 offset:6144
    ds_read_b64_tr_b16 a[8:9], v28 offset:8192
    ds_read_b64_tr_b16 a[10:11], v28 offset:10240
    ds_read_b64_tr_b16 a[12:13], v28 offset:12288
    ds_read_b64_tr_b16 a[14:15], v28 offset:14336
    ds_read_b64_tr_b16 a[16:17], v28 offset:16384
    ds_read_b64_tr_b16 a[18:19], v28 offset:18432
    ds_read_b64_tr_b16 a[20:21], v28 offset:20480
    ds_read_b64_tr_b16 a[22:23], v28 offset:22528
    ds_read_b128 v[72:75], v56 offset:0
    ds_read_b128 v[76:79], v56 offset:1024
    ds_read_b128 v[80:83], v56 offset:2048
    ds_read_b128 v[84:87], v56 offset:3072
    ds_read_b64 v[104:105], v49 offset:3552
    ds_read_b64 v[106:107], v49 offset:3560
    ds_read_b64 v[108:109], v49 offset:3520
    ds_read_b64 v[110:111], v49 offset:3528
    ds_read_b64 v[112:113], v49 offset:2528
    ds_read_b64 v[114:115], v49 offset:2536
    ds_read_b64 v[116:117], v49 offset:2496
    ds_read_b64 v[118:119], v49 offset:2504
    ds_read_b64 v[120:121], v49 offset:1504
    ds_read_b64 v[122:123], v49 offset:1512
    ds_read_b64 v[124:125], v49 offset:1472
    ds_read_b64 v[126:127], v49 offset:1480
    ds_read_b64 v[128:129], v49 offset:480
    ds_read_b64 v[130:131], v49 offset:488
    ds_read_b64 v[132:133], v49 offset:448
    ds_read_b64 v[134:135], v49 offset:456
    s_waitcnt lgkmcnt(14)
    s_waitcnt lgkmcnt(12)
    v_mfma_f32_16x16x32_bf16 v[136:139], v[104:107], v[72:75], 0
    v_mfma_f32_16x16x32_bf16 v[144:147], v[104:107], v[76:79], 0
    s_add_u32 s100, s14, 286720
    v_mfma_f32_16x16x32_bf16 v[152:155], v[104:107], v[80:83], 0
    v_mfma_f32_16x16x32_bf16 v[160:163], v[104:107], v[84:87], 0
    s_add_u32 m0, s81, 40960
    v_mfma_f32_16x16x32_bf16 v[140:143], v[108:111], v[72:75], 0
    ds_read_b64 v[104:105], v49 offset:3488
    v_mfma_f32_16x16x32_bf16 v[148:151], v[108:111], v[76:79], 0
    ds_read_b64 v[106:107], v49 offset:3496
    v_mfma_f32_16x16x32_bf16 v[156:159], v[108:111], v[80:83], 0
    buffer_load_dwordx4 v26, s[48:51], s100 offen lds
    v_mfma_f32_16x16x32_bf16 v[164:167], v[108:111], v[84:87], 0
    s_waitcnt lgkmcnt(10)
    v_mfma_f32_16x16x32_bf16 v[144:147], v[112:115], v[72:75], v[144:147]
    ds_read_b64 v[108:109], v49 offset:3456
    v_mfma_f32_16x16x32_bf16 v[152:155], v[112:115], v[76:79], v[152:155]
    ds_read_b64 v[110:111], v49 offset:3464
    v_mfma_f32_16x16x32_bf16 v[160:163], v[112:115], v[80:83], v[160:163]
    ds_read_b128 v[88:91], v57 offset:0
    s_add_u32 m0, s81, 45056
    v_mfma_f32_16x16x32_bf16 v[148:151], v[116:119], v[72:75], v[148:151]
    ds_read_b128 v[92:95], v57 offset:1024
    v_mfma_f32_16x16x32_bf16 v[156:159], v[116:119], v[76:79], v[156:159]
    ds_read_b128 v[96:99], v57 offset:2048
    v_mfma_f32_16x16x32_bf16 v[164:167], v[116:119], v[80:83], v[164:167]
    ds_read_b128 v[100:103], v57 offset:3072
    s_waitcnt lgkmcnt(12)
    v_mfma_f32_16x16x32_bf16 v[152:155], v[120:123], v[72:75], v[152:155]
    ds_read_b64 v[112:113], v49 offset:2464
    buffer_load_dwordx4 v26, s[52:55], s100 offen lds
    v_mfma_f32_16x16x32_bf16 v[160:163], v[120:123], v[76:79], v[160:163]
    ds_read_b64 v[114:115], v49 offset:2472
    v_mfma_f32_16x16x32_bf16 v[156:159], v[124:127], v[72:75], v[156:159]
    ds_read_b64 v[116:117], v49 offset:2432
    v_mfma_f32_16x16x32_bf16 v[164:167], v[124:127], v[76:79], v[164:167]
    ds_read_b64 v[118:119], v49 offset:2440
    s_waitcnt lgkmcnt(12)
    v_mfma_f32_16x16x32_bf16 v[160:163], v[128:131], v[72:75], v[160:163]
    ds_read_b64 v[120:121], v49 offset:1440
    v_mfma_f32_16x16x32_bf16 v[164:167], v[132:135], v[72:75], v[164:167]
    ds_read_b64 v[122:123], v49 offset:1448
    s_waitcnt lgkmcnt(6)
    v_mfma_f32_16x16x32_bf16 v[136:139], v[104:107], v[88:91], v[136:139]
    ds_read_b64 v[124:125], v49 offset:1408
    s_add_u32 s100, s14, 344064
    v_mfma_f32_16x16x32_bf16 v[144:147], v[104:107], v[92:95], v[144:147]
    ds_read_b64 v[126:127], v49 offset:1416
    v_mfma_f32_16x16x32_bf16 v[152:155], v[104:107], v[96:99], v[152:155]
    ds_read_b64 v[128:129], v49 offset:416
    v_mfma_f32_16x16x32_bf16 v[160:163], v[104:107], v[100:103], v[160:163]
    ds_read_b64 v[130:131], v49 offset:424
    v_mfma_f32_16x16x32_bf16 v[140:143], v[108:111], v[88:91], v[140:143]
    ds_read_b64 v[132:133], v49 offset:384
    s_add_u32 m0, s81, 49152
    v_mfma_f32_16x16x32_bf16 v[148:151], v[108:111], v[92:95], v[148:151]
    ds_read_b64 v[134:135], v49 offset:392
    v_mfma_f32_16x16x32_bf16 v[156:159], v[108:111], v[96:99], v[156:159]
    ds_read_b64 v[104:105], v49 offset:3424
    v_mfma_f32_16x16x32_bf16 v[164:167], v[108:111], v[100:103], v[164:167]
    ds_read_b64 v[106:107], v49 offset:3432
    s_waitcnt lgkmcnt(10)
    v_mfma_f32_16x16x32_bf16 v[144:147], v[112:115], v[88:91], v[144:147]
    ds_read_b64 v[108:109], v49 offset:3392
    v_mfma_f32_16x16x32_bf16 v[152:155], v[112:115], v[92:95], v[152:155]
    ds_read_b64 v[110:111], v49 offset:3400
    buffer_load_dwordx4 v26, s[48:51], s100 offen lds
    v_mfma_f32_16x16x32_bf16 v[160:163], v[112:115], v[96:99], v[160:163]
    ds_read_b128 v[72:75], v58 offset:0
    v_mfma_f32_16x16x32_bf16 v[148:151], v[116:119], v[88:91], v[148:151]
    ds_read_b128 v[76:79], v58 offset:1024
    v_mfma_f32_16x16x32_bf16 v[156:159], v[116:119], v[92:95], v[156:159]
    ds_read_b128 v[80:83], v58 offset:2048
    v_mfma_f32_16x16x32_bf16 v[164:167], v[116:119], v[96:99], v[164:167]
    ds_read_b128 v[84:87], v58 offset:3072
    s_waitcnt lgkmcnt(12)
    v_mfma_f32_16x16x32_bf16 v[152:155], v[120:123], v[88:91], v[152:155]
    ds_read_b64 v[112:113], v49 offset:2400
    s_add_u32 m0, s81, 53248
    v_mfma_f32_16x16x32_bf16 v[160:163], v[120:123], v[92:95], v[160:163]
    ds_read_b64 v[114:115], v49 offset:2408
    v_mfma_f32_16x16x32_bf16 v[156:159], v[124:127], v[88:91], v[156:159]
    ds_read_b64 v[116:117], v49 offset:2368
    v_mfma_f32_16x16x32_bf16 v[164:167], v[124:127], v[92:95], v[164:167]
    ds_read_b64 v[118:119], v49 offset:2376
    s_waitcnt lgkmcnt(12)
    v_mfma_f32_16x16x32_bf16 v[160:163], v[128:131], v[88:91], v[160:163]
    ds_read_b64 v[120:121], v49 offset:1376
    buffer_load_dwordx4 v26, s[52:55], s100 offen lds
    v_mfma_f32_16x16x32_bf16 v[164:167], v[132:135], v[88:91], v[164:167]
    ds_read_b64 v[122:123], v49 offset:1384
    s_waitcnt lgkmcnt(6)
    v_mfma_f32_16x16x32_bf16 v[136:139], v[104:107], v[72:75], v[136:139]
    ds_read_b64 v[124:125], v49 offset:1344
    v_mfma_f32_16x16x32_bf16 v[144:147], v[104:107], v[76:79], v[144:147]
    ds_read_b64 v[126:127], v49 offset:1352
    v_mfma_f32_16x16x32_bf16 v[152:155], v[104:107], v[80:83], v[152:155]
    ds_read_b64 v[128:129], v49 offset:352
    v_mfma_f32_16x16x32_bf16 v[160:163], v[104:107], v[84:87], v[160:163]
    ds_read_b64 v[130:131], v49 offset:360
    s_add_u32 s100, s15, 0
    v_mfma_f32_16x16x32_bf16 v[140:143], v[108:111], v[72:75], v[140:143]
    ds_read_b64 v[132:133], v49 offset:320
    v_mfma_f32_16x16x32_bf16 v[148:151], v[108:111], v[76:79], v[148:151]
    ds_read_b64 v[134:135], v49 offset:328
    v_mfma_f32_16x16x32_bf16 v[156:159], v[108:111], v[80:83], v[156:159]
    ds_read_b64 v[104:105], v49 offset:3360
    v_mfma_f32_16x16x32_bf16 v[164:167], v[108:111], v[84:87], v[164:167]
    ds_read_b64 v[106:107], v49 offset:3368
    s_waitcnt lgkmcnt(10)
    v_mfma_f32_16x16x32_bf16 v[144:147], v[112:115], v[72:75], v[144:147]
    ds_read_b64 v[108:109], v49 offset:3328
    s_add_u32 m0, s81, 57344
    v_mfma_f32_16x16x32_bf16 v[152:155], v[112:115], v[76:79], v[152:155]
    ds_read_b64 v[110:111], v49 offset:3336
    v_mfma_f32_16x16x32_bf16 v[160:163], v[112:115], v[80:83], v[160:163]
    ds_read_b128 v[88:91], v59 offset:0
    v_mfma_f32_16x16x32_bf16 v[148:151], v[116:119], v[72:75], v[148:151]
    ds_read_b128 v[92:95], v59 offset:1024
    v_mfma_f32_16x16x32_bf16 v[156:159], v[116:119], v[76:79], v[156:159]
    ds_read_b128 v[96:99], v59 offset:2048
    buffer_load_dwordx4 v26, s[48:51], s100 offen lds
    v_mfma_f32_16x16x32_bf16 v[164:167], v[116:119], v[80:83], v[164:167]
    ds_read_b128 v[100:103], v59 offset:3072
    s_waitcnt lgkmcnt(12)
    v_mfma_f32_16x16x32_bf16 v[152:155], v[120:123], v[72:75], v[152:155]
    ds_read_b64 v[112:113], v49 offset:2336
    v_mfma_f32_16x16x32_bf16 v[160:163], v[120:123], v[76:79], v[160:163]
    ds_read_b64 v[114:115], v49 offset:2344
    v_mfma_f32_16x16x32_bf16 v[156:159], v[124:127], v[72:75], v[156:159]
    ds_read_b64 v[116:117], v49 offset:2304
    v_mfma_f32_16x16x32_bf16 v[164:167], v[124:127], v[76:79], v[164:167]
    ds_read_b64 v[118:119], v49 offset:2312
    s_waitcnt lgkmcnt(12)
    v_mfma_f32_16x16x32_bf16 v[160:163], v[128:131], v[72:75], v[160:163]
    ds_read_b64 v[120:121], v49 offset:1312
    s_add_u32 m0, s81, 61440
    v_mfma_f32_16x16x32_bf16 v[164:167], v[132:135], v[72:75], v[164:167]
    ds_read_b64 v[122:123], v49 offset:1320
    s_waitcnt lgkmcnt(6)
    v_mfma_f32_16x16x32_bf16 v[136:139], v[104:107], v[88:91], v[136:139]
    ds_read_b64 v[124:125], v49 offset:1280
    v_mfma_f32_16x16x32_bf16 v[144:147], v[104:107], v[92:95], v[144:147]
    ds_read_b64 v[126:127], v49 offset:1288
    v_mfma_f32_16x16x32_bf16 v[152:155], v[104:107], v[96:99], v[152:155]
    ds_read_b64 v[128:129], v49 offset:288
    buffer_load_dwordx4 v26, s[52:55], s100 offen lds
    v_mfma_f32_16x16x32_bf16 v[160:163], v[104:107], v[100:103], v[160:163]
    ds_read_b64 v[130:131], v49 offset:296
    v_mfma_f32_16x16x32_bf16 v[140:143], v[108:111], v[88:91], v[140:143]
    ds_read_b64 v[132:133], v49 offset:256
    v_mfma_f32_16x16x32_bf16 v[148:151], v[108:111], v[92:95], v[148:151]
    ds_read_b64 v[134:135], v49 offset:264
    v_mfma_f32_16x16x32_bf16 v[156:159], v[108:111], v[96:99], v[156:159]
    ds_read_b64 v[104:105], v49 offset:3296
    s_add_u32 s100, s15, 57344
    v_mfma_f32_16x16x32_bf16 v[164:167], v[108:111], v[100:103], v[164:167]
    ds_read_b64 v[106:107], v49 offset:3304
    s_waitcnt lgkmcnt(10)
    v_mfma_f32_16x16x32_bf16 v[144:147], v[112:115], v[88:91], v[144:147]
    ds_read_b64 v[108:109], v49 offset:3264
    v_mfma_f32_16x16x32_bf16 v[152:155], v[112:115], v[92:95], v[152:155]
    ds_read_b64 v[110:111], v49 offset:3272
    v_mfma_f32_16x16x32_bf16 v[160:163], v[112:115], v[96:99], v[160:163]
    ds_read_b128 v[72:75], v60 offset:0
    v_mfma_f32_16x16x32_bf16 v[148:151], v[116:119], v[88:91], v[148:151]
    ds_read_b128 v[76:79], v60 offset:1024
    s_add_u32 m0, s81, 65536
    v_mfma_f32_16x16x32_bf16 v[156:159], v[116:119], v[92:95], v[156:159]
    ds_read_b128 v[80:83], v60 offset:2048
    v_mfma_f32_16x16x32_bf16 v[164:167], v[116:119], v[96:99], v[164:167]
    ds_read_b128 v[84:87], v60 offset:3072
    s_waitcnt lgkmcnt(12)
    v_mfma_f32_16x16x32_bf16 v[152:155], v[120:123], v[88:91], v[152:155]
    ds_read_b64 v[112:113], v49 offset:2272
    v_mfma_f32_16x16x32_bf16 v[160:163], v[120:123], v[92:95], v[160:163]
    ds_read_b64 v[114:115], v49 offset:2280
    v_mfma_f32_16x16x32_bf16 v[156:159], v[124:127], v[88:91], v[156:159]
    ds_read_b64 v[116:117], v49 offset:2240
    buffer_load_dwordx4 v26, s[48:51], s100 offen lds
    v_mfma_f32_16x16x32_bf16 v[164:167], v[124:127], v[92:95], v[164:167]
    ds_read_b64 v[118:119], v49 offset:2248
    s_waitcnt lgkmcnt(12)
    v_mfma_f32_16x16x32_bf16 v[160:163], v[128:131], v[88:91], v[160:163]
    ds_read_b64 v[120:121], v49 offset:1248
    v_mfma_f32_16x16x32_bf16 v[164:167], v[132:135], v[88:91], v[164:167]
    ds_read_b64 v[122:123], v49 offset:1256
    s_waitcnt lgkmcnt(6)
    v_mfma_f32_16x16x32_bf16 v[136:139], v[104:107], v[72:75], v[136:139]
    ds_read_b64 v[124:125], v49 offset:1216
    v_mfma_f32_16x16x32_bf16 v[144:147], v[104:107], v[76:79], v[144:147]
    ds_read_b64 v[126:127], v49 offset:1224
    v_mfma_f32_16x16x32_bf16 v[152:155], v[104:107], v[80:83], v[152:155]
    ds_read_b64 v[128:129], v49 offset:224
    s_add_u32 m0, s81, 69632
    v_mfma_f32_16x16x32_bf16 v[160:163], v[104:107], v[84:87], v[160:163]
    ds_read_b64 v[130:131], v49 offset:232
    v_mfma_f32_16x16x32_bf16 v[140:143], v[108:111], v[72:75], v[140:143]
    ds_read_b64 v[132:133], v49 offset:192
    v_mfma_f32_16x16x32_bf16 v[148:151], v[108:111], v[76:79], v[148:151]
    ds_read_b64 v[134:135], v49 offset:200
    buffer_load_dwordx4 v26, s[52:55], s100 offen lds
    v_mfma_f32_16x16x32_bf16 v[156:159], v[108:111], v[80:83], v[156:159]
    ds_read_b64 v[104:105], v49 offset:3232
    v_mfma_f32_16x16x32_bf16 v[164:167], v[108:111], v[84:87], v[164:167]
    ds_read_b64 v[106:107], v49 offset:3240
    s_waitcnt lgkmcnt(10)
    v_mfma_f32_16x16x32_bf16 v[144:147], v[112:115], v[72:75], v[144:147]
    ds_read_b64 v[108:109], v49 offset:3200
    v_mfma_f32_16x16x32_bf16 v[152:155], v[112:115], v[76:79], v[152:155]
    ds_read_b64 v[110:111], v49 offset:3208
    v_mfma_f32_16x16x32_bf16 v[160:163], v[112:115], v[80:83], v[160:163]
    ds_read_b128 v[88:91], v61 offset:0
    s_add_u32 s100, s15, 114688
    v_mfma_f32_16x16x32_bf16 v[148:151], v[116:119], v[72:75], v[148:151]
    ds_read_b128 v[92:95], v61 offset:1024
    v_mfma_f32_16x16x32_bf16 v[156:159], v[116:119], v[76:79], v[156:159]
    ds_read_b128 v[96:99], v61 offset:2048
    v_mfma_f32_16x16x32_bf16 v[164:167], v[116:119], v[80:83], v[164:167]
    ds_read_b128 v[100:103], v61 offset:3072
    s_waitcnt lgkmcnt(12)
    v_mfma_f32_16x16x32_bf16 v[152:155], v[120:123], v[72:75], v[152:155]
    ds_read_b64 v[112:113], v49 offset:2208
    v_mfma_f32_16x16x32_bf16 v[160:163], v[120:123], v[76:79], v[160:163]
    ds_read_b64 v[114:115], v49 offset:2216
    s_sub_u32 m0, s81, 12544
    v_mfma_f32_16x16x32_bf16 v[156:159], v[124:127], v[72:75], v[156:159]
    ds_read_b64 v[116:117], v49 offset:2176
    v_mfma_f32_16x16x32_bf16 v[164:167], v[124:127], v[76:79], v[164:167]
    ds_read_b64 v[118:119], v49 offset:2184
    s_waitcnt lgkmcnt(12)
    v_mfma_f32_16x16x32_bf16 v[160:163], v[128:131], v[72:75], v[160:163]
    ds_read_b64 v[120:121], v49 offset:1184
    v_mfma_f32_16x16x32_bf16 v[164:167], v[132:135], v[72:75], v[164:167]
    ds_read_b64 v[122:123], v49 offset:1192
    s_waitcnt lgkmcnt(6)
    v_mfma_f32_16x16x32_bf16 v[136:139], v[104:107], v[88:91], v[136:139]
    ds_read_b64 v[124:125], v49 offset:1152
    v_mfma_f32_16x16x32_bf16 v[144:147], v[104:107], v[92:95], v[144:147]
    ds_read_b64 v[126:127], v49 offset:1160
    buffer_load_dwordx4 v26, s[48:51], s100 offen lds
    v_mfma_f32_16x16x32_bf16 v[152:155], v[104:107], v[96:99], v[152:155]
    ds_read_b64 v[128:129], v49 offset:160
    v_mfma_f32_16x16x32_bf16 v[160:163], v[104:107], v[100:103], v[160:163]
    ds_read_b64 v[130:131], v49 offset:168
    v_mfma_f32_16x16x32_bf16 v[140:143], v[108:111], v[88:91], v[140:143]
    ds_read_b64 v[132:133], v49 offset:128
    v_mfma_f32_16x16x32_bf16 v[148:151], v[108:111], v[92:95], v[148:151]
    ds_read_b64 v[134:135], v49 offset:136
    s_sub_u32 m0, s81, 8448
    v_mfma_f32_16x16x32_bf16 v[156:159], v[108:111], v[96:99], v[156:159]
    ds_read_b64 v[104:105], v49 offset:3168
    v_mfma_f32_16x16x32_bf16 v[164:167], v[108:111], v[100:103], v[164:167]
    ds_read_b64 v[106:107], v49 offset:3176
    s_waitcnt lgkmcnt(10)
    v_mfma_f32_16x16x32_bf16 v[144:147], v[112:115], v[88:91], v[144:147]
    ds_read_b64 v[108:109], v49 offset:3136
    v_mfma_f32_16x16x32_bf16 v[152:155], v[112:115], v[92:95], v[152:155]
    ds_read_b64 v[110:111], v49 offset:3144
    buffer_load_dwordx4 v26, s[52:55], s100 offen lds
    v_mfma_f32_16x16x32_bf16 v[160:163], v[112:115], v[96:99], v[160:163]
    ds_read_b128 v[72:75], v62 offset:0
    v_mfma_f32_16x16x32_bf16 v[148:151], v[116:119], v[88:91], v[148:151]
    ds_read_b128 v[76:79], v62 offset:1024
    v_mfma_f32_16x16x32_bf16 v[156:159], v[116:119], v[92:95], v[156:159]
    ds_read_b128 v[80:83], v62 offset:2048
    v_mfma_f32_16x16x32_bf16 v[164:167], v[116:119], v[96:99], v[164:167]
    ds_read_b128 v[84:87], v62 offset:3072
    s_waitcnt lgkmcnt(12)
    v_mfma_f32_16x16x32_bf16 v[152:155], v[120:123], v[88:91], v[152:155]
    ds_read_b64 v[112:113], v49 offset:2144
    v_mfma_f32_16x16x32_bf16 v[160:163], v[120:123], v[92:95], v[160:163]
    ds_read_b64 v[114:115], v49 offset:2152
    v_mfma_f32_16x16x32_bf16 v[156:159], v[124:127], v[88:91], v[156:159]
    ds_read_b64 v[116:117], v49 offset:2112
    v_mfma_f32_16x16x32_bf16 v[164:167], v[124:127], v[92:95], v[164:167]
    ds_read_b64 v[118:119], v49 offset:2120
    s_waitcnt lgkmcnt(12)
    v_mfma_f32_16x16x32_bf16 v[160:163], v[128:131], v[88:91], v[160:163]
    ds_read_b64 v[120:121], v49 offset:1120
    v_mfma_f32_16x16x32_bf16 v[164:167], v[132:135], v[88:91], v[164:167]
    ds_read_b64 v[122:123], v49 offset:1128
    s_waitcnt lgkmcnt(6)
    v_mfma_f32_16x16x32_bf16 v[136:139], v[104:107], v[72:75], v[136:139]
    ds_read_b64 v[124:125], v49 offset:1088
    v_mfma_f32_16x16x32_bf16 v[144:147], v[104:107], v[76:79], v[144:147]
    ds_read_b64 v[126:127], v49 offset:1096
    v_mfma_f32_16x16x32_bf16 v[152:155], v[104:107], v[80:83], v[152:155]
    ds_read_b64 v[128:129], v49 offset:96
    v_mfma_f32_16x16x32_bf16 v[160:163], v[104:107], v[84:87], v[160:163]
    ds_read_b64 v[130:131], v49 offset:104
    v_mfma_f32_16x16x32_bf16 v[140:143], v[108:111], v[72:75], v[140:143]
    ds_read_b64 v[132:133], v49 offset:64
    v_mfma_f32_16x16x32_bf16 v[148:151], v[108:111], v[76:79], v[148:151]
    ds_read_b64 v[134:135], v49 offset:72
    v_mfma_f32_16x16x32_bf16 v[156:159], v[108:111], v[80:83], v[156:159]
    ds_read_b64 v[104:105], v49 offset:3104
    v_mfma_f32_16x16x32_bf16 v[164:167], v[108:111], v[84:87], v[164:167]
    ds_read_b64 v[106:107], v49 offset:3112
    s_waitcnt lgkmcnt(10)
    v_mfma_f32_16x16x32_bf16 v[144:147], v[112:115], v[72:75], v[144:147]
    ds_read_b64 v[108:109], v49 offset:3072
    v_mfma_f32_16x16x32_bf16 v[152:155], v[112:115], v[76:79], v[152:155]
    ds_read_b64 v[110:111], v49 offset:3080
    v_mfma_f32_16x16x32_bf16 v[160:163], v[112:115], v[80:83], v[160:163]
    ds_read_b128 v[88:91], v63 offset:0
    v_mfma_f32_16x16x32_bf16 v[148:151], v[116:119], v[72:75], v[148:151]
    ds_read_b128 v[92:95], v63 offset:1024
    v_mfma_f32_16x16x32_bf16 v[156:159], v[116:119], v[76:79], v[156:159]
    ds_read_b128 v[96:99], v63 offset:2048
    v_mfma_f32_16x16x32_bf16 v[164:167], v[116:119], v[80:83], v[164:167]
    ds_read_b128 v[100:103], v63 offset:3072
    s_waitcnt lgkmcnt(12)
    v_mfma_f32_16x16x32_bf16 v[152:155], v[120:123], v[72:75], v[152:155]
    ds_read_b64 v[112:113], v49 offset:2080
    v_mfma_f32_16x16x32_bf16 v[160:163], v[120:123], v[76:79], v[160:163]
    ds_read_b64 v[114:115], v49 offset:2088
    v_mfma_f32_16x16x32_bf16 v[156:159], v[124:127], v[72:75], v[156:159]
    ds_read_b64 v[116:117], v49 offset:2048
    v_mfma_f32_16x16x32_bf16 v[164:167], v[124:127], v[76:79], v[164:167]
    ds_read_b64 v[118:119], v49 offset:2056
    s_waitcnt lgkmcnt(12)
    v_mfma_f32_16x16x32_bf16 v[160:163], v[128:131], v[72:75], v[160:163]
    ds_read_b64 v[120:121], v49 offset:1056
    v_mfma_f32_16x16x32_bf16 v[164:167], v[132:135], v[72:75], v[164:167]
    ds_read_b64 v[122:123], v49 offset:1064
    s_waitcnt lgkmcnt(6)
    v_mfma_f32_16x16x32_bf16 v[136:139], v[104:107], v[88:91], v[136:139]
    ds_read_b64 v[124:125], v49 offset:1024
    v_mfma_f32_16x16x32_bf16 v[144:147], v[104:107], v[92:95], v[144:147]
    ds_read_b64 v[126:127], v49 offset:1032
    v_mfma_f32_16x16x32_bf16 v[152:155], v[104:107], v[96:99], v[152:155]
    ds_read_b64 v[128:129], v49 offset:32
    v_mfma_f32_16x16x32_bf16 v[160:163], v[104:107], v[100:103], v[160:163]
    ds_read_b64 v[130:131], v49 offset:40
    v_mfma_f32_16x16x32_bf16 v[140:143], v[108:111], v[88:91], v[140:143]
    ds_read_b64 v[132:133], v49 offset:0
    v_mfma_f32_16x16x32_bf16 v[148:151], v[108:111], v[92:95], v[148:151]
    ds_read_b64 v[134:135], v49 offset:8
    v_mfma_f32_16x16x32_bf16 v[156:159], v[108:111], v[96:99], v[156:159]
    v_mfma_f32_16x16x32_bf16 v[164:167], v[108:111], v[100:103], v[164:167]
    s_waitcnt lgkmcnt(8)
    v_mfma_f32_16x16x32_bf16 v[144:147], v[112:115], v[88:91], v[144:147]
    v_mfma_f32_16x16x32_bf16 v[152:155], v[112:115], v[92:95], v[152:155]
    v_mfma_f32_16x16x32_bf16 v[160:163], v[112:115], v[96:99], v[160:163]
    v_mfma_f32_16x16x32_bf16 v[148:151], v[116:119], v[88:91], v[148:151]
    v_mfma_f32_16x16x32_bf16 v[156:159], v[116:119], v[92:95], v[156:159]
    v_mfma_f32_16x16x32_bf16 v[164:167], v[116:119], v[96:99], v[164:167]
    s_waitcnt lgkmcnt(4)
    v_mfma_f32_16x16x32_bf16 v[152:155], v[120:123], v[88:91], v[152:155]
    v_mfma_f32_16x16x32_bf16 v[160:163], v[120:123], v[92:95], v[160:163]
    v_mfma_f32_16x16x32_bf16 v[156:159], v[124:127], v[88:91], v[156:159]
    v_mfma_f32_16x16x32_bf16 v[164:167], v[124:127], v[92:95], v[164:167]
    s_waitcnt lgkmcnt(0)
    v_mfma_f32_16x16x32_bf16 v[160:163], v[128:131], v[88:91], v[160:163]
    v_mfma_f32_16x16x32_bf16 v[164:167], v[132:135], v[88:91], v[164:167]
    ds_read_b128 v[12:15], v66 offset:34304
    ds_read_b128 v[36:39], v67 offset:43520
    ds_read_b128 v[16:19], v66 offset:35328
    ds_read_b128 v[40:43], v67 offset:44544
    v_mov_b32 v2, s76
    s_and_b32 s74, s64, 1
    s_cmp_lg_u32 s74, 0
    s_cbranch_scc1 Lp1_23
    ds_write_b128 v68, v[152:155] offset:0
    ds_write_b128 v68, v[156:159] offset:1024
    ds_write_b128 v68, v[160:163] offset:2048
    ds_write_b128 v68, v[164:167] offset:3072
    s_waitcnt lgkmcnt(4)
    v_lshlrev_b32 v50, 16, v12
    v_and_b32 v51, 0xffff0000, v12
    v_lshlrev_b32 v52, 16, v13
    v_and_b32 v53, 0xffff0000, v13
    v_lshlrev_b32 v54, 16, v14
    v_and_b32 v55, 0xffff0000, v14
    v_lshlrev_b32 v56, 16, v15
    v_and_b32 v57, 0xffff0000, v15
    v_lshlrev_b32 v58, 16, v16
    v_and_b32 v59, 0xffff0000, v16
    v_lshlrev_b32 v60, 16, v17
    v_and_b32 v61, 0xffff0000, v17
    v_lshlrev_b32 v62, 16, v18
    v_and_b32 v63, 0xffff0000, v18
    v_lshlrev_b32 v64, 16, v19
    v_and_b32 v65, 0xffff0000, v19
    v_pk_mul_f32 v[50:51], v[50:51], v[2:3] op_sel_hi:[1,0]
    v_pk_mul_f32 v[52:53], v[52:53], v[2:3] op_sel_hi:[1,0]
    v_pk_mul_f32 v[54:55], v[54:55], v[2:3] op_sel_hi:[1,0]
    v_pk_mul_f32 v[56:57], v[56:57], v[2:3] op_sel_hi:[1,0]
    v_pk_mul_f32 v[58:59], v[58:59], v[2:3] op_sel_hi:[1,0]
    v_pk_mul_f32 v[60:61], v[60:61], v[2:3] op_sel_hi:[1,0]
    v_pk_mul_f32 v[62:63], v[62:63], v[2:3] op_sel_hi:[1,0]
    v_pk_mul_f32 v[64:65], v[64:65], v[2:3] op_sel_hi:[1,0]
    v_cvt_pk_bf16_f32 v12, v50, v51
    v_cvt_pk_bf16_f32 v13, v52, v53
    v_cvt_pk_bf16_f32 v14, v54, v55
    v_cvt_pk_bf16_f32 v15, v56, v57
    v_cvt_pk_bf16_f32 v16, v58, v59
    v_cvt_pk_bf16_f32 v17, v60, v61
    v_cvt_pk_bf16_f32 v18, v62, v63
    v_cvt_pk_bf16_f32 v19, v64, v65
    v_lshlrev_b32 v72, 16, v36
    v_and_b32 v73, 0xffff0000, v36
    v_lshlrev_b32 v74, 16, v37
    v_and_b32 v75, 0xffff0000, v37
    v_lshlrev_b32 v76, 16, v38
    v_and_b32 v77, 0xffff0000, v38
    v_lshlrev_b32 v78, 16, v39
    v_and_b32 v79, 0xffff0000, v39
    v_lshlrev_b32 v80, 16, v40
    v_and_b32 v81, 0xffff0000, v40
    v_lshlrev_b32 v82, 16, v41
    v_and_b32 v83, 0xffff0000, v41
    v_lshlrev_b32 v84, 16, v42
    v_and_b32 v85, 0xffff0000, v42
    v_lshlrev_b32 v86, 16, v43
    v_and_b32 v87, 0xffff0000, v43
    v_lshlrev_b32 v50, 16, v12
    v_and_b32 v51, 0xffff0000, v12
    v_lshlrev_b32 v52, 16, v13
    v_and_b32 v53, 0xffff0000, v13
    v_lshlrev_b32 v54, 16, v14
    v_and_b32 v55, 0xffff0000, v14
    v_lshlrev_b32 v56, 16, v15
    v_and_b32 v57, 0xffff0000, v15
    v_lshlrev_b32 v58, 16, v16
    v_and_b32 v59, 0xffff0000, v16
    v_lshlrev_b32 v60, 16, v17
    v_and_b32 v61, 0xffff0000, v17
    v_lshlrev_b32 v62, 16, v18
    v_and_b32 v63, 0xffff0000, v18
    v_lshlrev_b32 v64, 16, v19
    v_and_b32 v65, 0xffff0000, v19
    s_waitcnt vmcnt(0)
    s_waitcnt lgkmcnt(0)
    s_barrier
    ds_read_b128 v[88:91], v69 offset:0
    ds_read_b128 v[92:95], v69 offset:1024
    ds_read_b128 v[96:99], v69 offset:2048
    ds_read_b128 v[100:103], v69 offset:3072
    s_waitcnt lgkmcnt(0)
    v_pk_add_f32 v[136:137], v[136:137], v[88:89]
    v_pk_add_f32 v[138:139], v[138:139], v[90:91]
    v_pk_add_f32 v[140:141], v[140:141], v[92:93]
    v_pk_add_f32 v[142:143], v[142:143], v[94:95]
    v_pk_add_f32 v[144:145], v[144:145], v[96:97]
    v_pk_add_f32 v[146:147], v[146:147], v[98:99]
    v_pk_add_f32 v[148:149], v[148:149], v[100:101]
    v_pk_add_f32 v[150:151], v[150:151], v[102:103]
    v_cvt_pk_bf16_f32 v104, v136, v137
    v_cvt_pk_bf16_f32 v105, v138, v139
    v_cvt_pk_bf16_f32 v106, v140, v141
    v_cvt_pk_bf16_f32 v107, v142, v143
    v_cvt_pk_bf16_f32 v108, v144, v145
    v_cvt_pk_bf16_f32 v109, v146, v147
    v_cvt_pk_bf16_f32 v110, v148, v149
    v_cvt_pk_bf16_f32 v111, v150, v151
    v_permlane32_swap_b32 v104, v106
    v_permlane32_swap_b32 v105, v107
    v_permlane32_swap_b32 v108, v110
    v_permlane32_swap_b32 v109, v111
    v_permlane16_swap_b32 v104, v106
    v_permlane16_swap_b32 v105, v107
    v_permlane16_swap_b32 v108, v110
    v_permlane16_swap_b32 v109, v111
    v_lshlrev_b32 v112, 16, v104
    v_and_b32 v113, 0xffff0000, v104
    v_lshlrev_b32 v114, 16, v105
    v_and_b32 v115, 0xffff0000, v105
    v_lshlrev_b32 v116, 16, v106
    v_and_b32 v117, 0xffff0000, v106
    v_lshlrev_b32 v118, 16, v107
    v_and_b32 v119, 0xffff0000, v107
    v_lshlrev_b32 v120, 16, v108
    v_and_b32 v121, 0xffff0000, v108
    v_lshlrev_b32 v122, 16, v109
    v_and_b32 v123, 0xffff0000, v109
    v_lshlrev_b32 v124, 16, v110
    v_and_b32 v125, 0xffff0000, v110
    v_lshlrev_b32 v126, 16, v111
    v_and_b32 v127, 0xffff0000, v111
    v_pk_add_f32 v[112:113], v[112:113], v[50:51]
    v_pk_add_f32 v[114:115], v[114:115], v[52:53]
    v_pk_add_f32 v[116:117], v[116:117], v[54:55]
    v_pk_add_f32 v[118:119], v[118:119], v[56:57]
    v_pk_add_f32 v[120:121], v[120:121], v[58:59]
    v_pk_add_f32 v[122:123], v[122:123], v[60:61]
    v_pk_add_f32 v[124:125], v[124:125], v[62:63]
    v_pk_add_f32 v[126:127], v[126:127], v[64:65]
    v_cvt_pk_bf16_f32 v104, v112, v113
    v_cvt_pk_bf16_f32 v105, v114, v115
    v_cvt_pk_bf16_f32 v106, v116, v117
    v_cvt_pk_bf16_f32 v107, v118, v119
    v_cvt_pk_bf16_f32 v108, v120, v121
    v_cvt_pk_bf16_f32 v109, v122, v123
    v_cvt_pk_bf16_f32 v110, v124, v125
    v_cvt_pk_bf16_f32 v111, v126, v127
    v_lshlrev_b32 v112, 16, v104
    v_and_b32 v113, 0xffff0000, v104
    v_lshlrev_b32 v114, 16, v105
    v_and_b32 v115, 0xffff0000, v105
    v_lshlrev_b32 v116, 16, v106
    v_and_b32 v117, 0xffff0000, v106
    v_lshlrev_b32 v118, 16, v107
    v_and_b32 v119, 0xffff0000, v107
    v_lshlrev_b32 v120, 16, v108
    v_and_b32 v121, 0xffff0000, v108
    v_lshlrev_b32 v122, 16, v109
    v_and_b32 v123, 0xffff0000, v109
    v_lshlrev_b32 v124, 16, v110
    v_and_b32 v125, 0xffff0000, v110
    v_lshlrev_b32 v126, 16, v111
    v_and_b32 v127, 0xffff0000, v111
    v_pk_add_f32 v[112:113], v[112:113], v[72:73]
    v_pk_add_f32 v[114:115], v[114:115], v[74:75]
    v_pk_add_f32 v[116:117], v[116:117], v[76:77]
    v_pk_add_f32 v[118:119], v[118:119], v[78:79]
    v_pk_add_f32 v[120:121], v[120:121], v[80:81]
    v_pk_add_f32 v[122:123], v[122:123], v[82:83]
    v_pk_add_f32 v[124:125], v[124:125], v[84:85]
    v_pk_add_f32 v[126:127], v[126:127], v[86:87]
    v_cvt_pk_bf16_f32 v104, v112, v113
    v_cvt_pk_bf16_f32 v105, v114, v115
    v_cvt_pk_bf16_f32 v106, v116, v117
    v_cvt_pk_bf16_f32 v107, v118, v119
    buffer_store_dwordx4 v[104:107], v70, s[40:43], 0 offen offset:0 sc1
    v_cvt_pk_bf16_f32 v108, v120, v121
    v_cvt_pk_bf16_f32 v109, v122, v123
    v_cvt_pk_bf16_f32 v110, v124, v125
    v_cvt_pk_bf16_f32 v111, v126, v127
    buffer_store_dwordx4 v[108:111], v70, s[40:43], 0 offen offset:1024 sc1
    s_branch Lpd_24
Lp1_23:
    s_nop 7
    ds_write_b128 v68, v[136:139] offset:0
    ds_write_b128 v68, v[140:143] offset:1024
    ds_write_b128 v68, v[144:147] offset:2048
    ds_write_b128 v68, v[148:151] offset:3072
    s_waitcnt lgkmcnt(4)
    v_lshlrev_b32 v50, 16, v12
    v_and_b32 v51, 0xffff0000, v12
    v_lshlrev_b32 v52, 16, v13
    v_and_b32 v53, 0xffff0000, v13
    v_lshlrev_b32 v54, 16, v14
    v_and_b32 v55, 0xffff0000, v14
    v_lshlrev_b32 v56, 16, v15
    v_and_b32 v57, 0xffff0000, v15
    v_lshlrev_b32 v58, 16, v16
    v_and_b32 v59, 0xffff0000, v16
    v_lshlrev_b32 v60, 16, v17
    v_and_b32 v61, 0xffff0000, v17
    v_lshlrev_b32 v62, 16, v18
    v_and_b32 v63, 0xffff0000, v18
    v_lshlrev_b32 v64, 16, v19
    v_and_b32 v65, 0xffff0000, v19
    v_pk_mul_f32 v[50:51], v[50:51], v[2:3] op_sel_hi:[1,0]
    v_pk_mul_f32 v[52:53], v[52:53], v[2:3] op_sel_hi:[1,0]
    v_pk_mul_f32 v[54:55], v[54:55], v[2:3] op_sel_hi:[1,0]
    v_pk_mul_f32 v[56:57], v[56:57], v[2:3] op_sel_hi:[1,0]
    v_pk_mul_f32 v[58:59], v[58:59], v[2:3] op_sel_hi:[1,0]
    v_pk_mul_f32 v[60:61], v[60:61], v[2:3] op_sel_hi:[1,0]
    v_pk_mul_f32 v[62:63], v[62:63], v[2:3] op_sel_hi:[1,0]
    v_pk_mul_f32 v[64:65], v[64:65], v[2:3] op_sel_hi:[1,0]
    v_cvt_pk_bf16_f32 v12, v50, v51
    v_cvt_pk_bf16_f32 v13, v52, v53
    v_cvt_pk_bf16_f32 v14, v54, v55
    v_cvt_pk_bf16_f32 v15, v56, v57
    v_cvt_pk_bf16_f32 v16, v58, v59
    v_cvt_pk_bf16_f32 v17, v60, v61
    v_cvt_pk_bf16_f32 v18, v62, v63
    v_cvt_pk_bf16_f32 v19, v64, v65
    v_lshlrev_b32 v72, 16, v36
    v_and_b32 v73, 0xffff0000, v36
    v_lshlrev_b32 v74, 16, v37
    v_and_b32 v75, 0xffff0000, v37
    v_lshlrev_b32 v76, 16, v38
    v_and_b32 v77, 0xffff0000, v38
    v_lshlrev_b32 v78, 16, v39
    v_and_b32 v79, 0xffff0000, v39
    v_lshlrev_b32 v80, 16, v40
    v_and_b32 v81, 0xffff0000, v40
    v_lshlrev_b32 v82, 16, v41
    v_and_b32 v83, 0xffff0000, v41
    v_lshlrev_b32 v84, 16, v42
    v_and_b32 v85, 0xffff0000, v42
    v_lshlrev_b32 v86, 16, v43
    v_and_b32 v87, 0xffff0000, v43
    v_lshlrev_b32 v50, 16, v12
    v_and_b32 v51, 0xffff0000, v12
    v_lshlrev_b32 v52, 16, v13
    v_and_b32 v53, 0xffff0000, v13
    v_lshlrev_b32 v54, 16, v14
    v_and_b32 v55, 0xffff0000, v14
    v_lshlrev_b32 v56, 16, v15
    v_and_b32 v57, 0xffff0000, v15
    v_lshlrev_b32 v58, 16, v16
    v_and_b32 v59, 0xffff0000, v16
    v_lshlrev_b32 v60, 16, v17
    v_and_b32 v61, 0xffff0000, v17
    v_lshlrev_b32 v62, 16, v18
    v_and_b32 v63, 0xffff0000, v18
    v_lshlrev_b32 v64, 16, v19
    v_and_b32 v65, 0xffff0000, v19
    s_waitcnt vmcnt(0)
    s_waitcnt lgkmcnt(0)
    s_barrier
    ds_read_b128 v[88:91], v69 offset:0
    ds_read_b128 v[92:95], v69 offset:1024
    ds_read_b128 v[96:99], v69 offset:2048
    ds_read_b128 v[100:103], v69 offset:3072
    s_waitcnt lgkmcnt(0)
    v_pk_add_f32 v[152:153], v[152:153], v[88:89]
    v_pk_add_f32 v[154:155], v[154:155], v[90:91]
    v_pk_add_f32 v[156:157], v[156:157], v[92:93]
    v_pk_add_f32 v[158:159], v[158:159], v[94:95]
    v_pk_add_f32 v[160:161], v[160:161], v[96:97]
    v_pk_add_f32 v[162:163], v[162:163], v[98:99]
    v_pk_add_f32 v[164:165], v[164:165], v[100:101]
    v_pk_add_f32 v[166:167], v[166:167], v[102:103]
    v_cvt_pk_bf16_f32 v104, v152, v153
    v_cvt_pk_bf16_f32 v105, v154, v155
    v_cvt_pk_bf16_f32 v106, v156, v157
    v_cvt_pk_bf16_f32 v107, v158, v159
    v_cvt_pk_bf16_f32 v108, v160, v161
    v_cvt_pk_bf16_f32 v109, v162, v163
    v_cvt_pk_bf16_f32 v110, v164, v165
    v_cvt_pk_bf16_f32 v111, v166, v167
    v_permlane32_swap_b32 v104, v106
    v_permlane32_swap_b32 v105, v107
    v_permlane32_swap_b32 v108, v110
    v_permlane32_swap_b32 v109, v111
    v_permlane16_swap_b32 v104, v106
    v_permlane16_swap_b32 v105, v107
    v_permlane16_swap_b32 v108, v110
    v_permlane16_swap_b32 v109, v111
    v_lshlrev_b32 v112, 16, v104
    v_and_b32 v113, 0xffff0000, v104
    v_lshlrev_b32 v114, 16, v105
    v_and_b32 v115, 0xffff0000, v105
    v_lshlrev_b32 v116, 16, v106
    v_and_b32 v117, 0xffff0000, v106
    v_lshlrev_b32 v118, 16, v107
    v_and_b32 v119, 0xffff0000, v107
    v_lshlrev_b32 v120, 16, v108
    v_and_b32 v121, 0xffff0000, v108
    v_lshlrev_b32 v122, 16, v109
    v_and_b32 v123, 0xffff0000, v109
    v_lshlrev_b32 v124, 16, v110
    v_and_b32 v125, 0xffff0000, v110
    v_lshlrev_b32 v126, 16, v111
    v_and_b32 v127, 0xffff0000, v111
    v_pk_add_f32 v[112:113], v[112:113], v[50:51]
    v_pk_add_f32 v[114:115], v[114:115], v[52:53]
    v_pk_add_f32 v[116:117], v[116:117], v[54:55]
    v_pk_add_f32 v[118:119], v[118:119], v[56:57]
    v_pk_add_f32 v[120:121], v[120:121], v[58:59]
    v_pk_add_f32 v[122:123], v[122:123], v[60:61]
    v_pk_add_f32 v[124:125], v[124:125], v[62:63]
    v_pk_add_f32 v[126:127], v[126:127], v[64:65]
    v_cvt_pk_bf16_f32 v104, v112, v113
    v_cvt_pk_bf16_f32 v105, v114, v115
    v_cvt_pk_bf16_f32 v106, v116, v117
    v_cvt_pk_bf16_f32 v107, v118, v119
    v_cvt_pk_bf16_f32 v108, v120, v121
    v_cvt_pk_bf16_f32 v109, v122, v123
    v_cvt_pk_bf16_f32 v110, v124, v125
    v_cvt_pk_bf16_f32 v111, v126, v127
    v_lshlrev_b32 v112, 16, v104
    v_and_b32 v113, 0xffff0000, v104
    v_lshlrev_b32 v114, 16, v105
    v_and_b32 v115, 0xffff0000, v105
    v_lshlrev_b32 v116, 16, v106
    v_and_b32 v117, 0xffff0000, v106
    v_lshlrev_b32 v118, 16, v107
    v_and_b32 v119, 0xffff0000, v107
    v_lshlrev_b32 v120, 16, v108
    v_and_b32 v121, 0xffff0000, v108
    v_lshlrev_b32 v122, 16, v109
    v_and_b32 v123, 0xffff0000, v109
    v_lshlrev_b32 v124, 16, v110
    v_and_b32 v125, 0xffff0000, v110
    v_lshlrev_b32 v126, 16, v111
    v_and_b32 v127, 0xffff0000, v111
    v_pk_add_f32 v[112:113], v[112:113], v[72:73]
    v_pk_add_f32 v[114:115], v[114:115], v[74:75]
    v_pk_add_f32 v[116:117], v[116:117], v[76:77]
    v_pk_add_f32 v[118:119], v[118:119], v[78:79]
    v_pk_add_f32 v[120:121], v[120:121], v[80:81]
    v_pk_add_f32 v[122:123], v[122:123], v[82:83]
    v_pk_add_f32 v[124:125], v[124:125], v[84:85]
    v_pk_add_f32 v[126:127], v[126:127], v[86:87]
    v_cvt_pk_bf16_f32 v104, v112, v113
    v_cvt_pk_bf16_f32 v105, v114, v115
    v_cvt_pk_bf16_f32 v106, v116, v117
    v_cvt_pk_bf16_f32 v107, v118, v119
    buffer_store_dwordx4 v[104:107], v70, s[40:43], 0 offen offset:0 sc1
    v_cvt_pk_bf16_f32 v108, v120, v121
    v_cvt_pk_bf16_f32 v109, v122, v123
    v_cvt_pk_bf16_f32 v110, v124, v125
    v_cvt_pk_bf16_f32 v111, v126, v127
    buffer_store_dwordx4 v[108:111], v70, s[40:43], 0 offen offset:1024 sc1
Lpd_24:
    ds_read_b64_tr_b16 a[24:25], v28 offset:24576
    ds_read_b64_tr_b16 a[26:27], v28 offset:26624
    ds_read_b64_tr_b16 a[28:29], v28 offset:28672
    ds_read_b64_tr_b16 a[30:31], v28 offset:30720
    ds_read_b64_tr_b16 a[32:33], v28 offset:32768
    ds_read_b64_tr_b16 a[34:35], v28 offset:34816
    ds_read_b64_tr_b16 a[36:37], v28 offset:36864
    ds_read_b64_tr_b16 a[38:39], v28 offset:38912
    ds_read_b64_tr_b16 a[40:41], v28 offset:40960
    ds_read_b64_tr_b16 a[42:43], v28 offset:43008
    ds_read_b64_tr_b16 a[44:45], v28 offset:45056
    ds_read_b64_tr_b16 a[46:47], v28 offset:47104
    ds_read_b64_tr_b16 a[48:49], v28 offset:49152
    ds_read_b64_tr_b16 a[50:51], v28 offset:51200
    ds_read_b64_tr_b16 a[52:53], v28 offset:53248
    ds_read_b64_tr_b16 a[54:55], v28 offset:55296
    ds_read_b64_tr_b16 a[56:57], v28 offset:57344
    ds_read_b64_tr_b16 a[58:59], v28 offset:59392
    ds_read_b64_tr_b16 a[60:61], v28 offset:61440
    ds_read_b64_tr_b16 a[62:63], v28 offset:63488
    ds_read_b64_tr_b16 a[64:65], v30 offset:0
    ds_read_b64_tr_b16 a[66:67], v30 offset:2048
    ds_read_b64_tr_b16 a[68:69], v30 offset:4096
    ds_read_b64_tr_b16 a[70:71], v30 offset:6144
    ds_read_b64_tr_b16 a[72:73], v29 offset:0
    ds_read_b64_tr_b16 a[74:75], v29 offset:2048
    ds_read_b64_tr_b16 a[76:77], v29 offset:4096
    ds_read_b64_tr_b16 a[78:79], v29 offset:6144
    s_add_u32 s100, s15, 172032
    s_add_u32 m0, s81, 0
    s_nop 0
    buffer_load_dwordx4 v26, s[48:51], s100 offen lds
    s_add_u32 m0, s81, 4096
    s_nop 0
    buffer_load_dwordx4 v26, s[52:55], s100 offen lds
    s_add_u32 s100, s15, 229376
    s_add_u32 m0, s81, 8192
    s_nop 0
    buffer_load_dwordx4 v26, s[48:51], s100 offen lds
    s_add_u32 m0, s81, 12288
    s_nop 0
    buffer_load_dwordx4 v26, s[52:55], s100 offen lds
    s_add_u32 s100, s15, 286720
    s_add_u32 m0, s81, 16384
    s_nop 0
    buffer_load_dwordx4 v26, s[48:51], s100 offen lds
    s_add_u32 m0, s81, 20480
    s_nop 0
    buffer_load_dwordx4 v26, s[52:55], s100 offen lds
    s_waitcnt vmcnt(6)
    s_waitcnt lgkmcnt(0)
    s_barrier
    s_cmp_lg_u32 s64, 0
    s_cbranch_scc1 Lsig_25
    s_mul_i32 s69, s2, 16
    s_add_u32 s69, s69, 16384
    v_mov_b32 v2, s65
    v_mov_b32 v3, s69
    s_mov_b64 s[84:85], exec
    s_mov_b64 exec, 1
    buffer_store_dword v2, v3, s[40:43], 0 offen sc1
    s_mov_b64 exec, s[84:85]
Lsig_25:
    v_mov_b32 v4, 0x3f803f80
    v_mov_b32 v5, 0x3f803f80
    v_mov_b32 v6, 0x3f803f80
    v_mov_b32 v7, 0x3f803f80
    s_add_u32 s100, s15, 344064
    s_add_u32 m0, s81, 24576
    v_lshrrev_b32 v9, 2, v1
    v_mul_u32_u24 v2, 4352, v9
    v_bfe_u32 v10, v1, 4, 1
    v_lshlrev_b32 v10, 1, v10
    v_and_b32 v9, 3, v1
    buffer_load_dwordx4 v26, s[48:51], s100 offen lds
    s_add_u32 m0, s81, 28672
    v_xor_b32 v9, v9, v10
    v_lshl_add_u32 v2, v9, 4, v2
    s_lshl_b32 s69, s77, 8
    s_add_u32 s69, s69, 131072
    v_add_u32 v2, s69, v2
    buffer_load_dwordx4 v26, s[52:55], s100 offen lds
    s_add_u32 s100, s16, 0
    s_mul_i32 s74, s64, 69632
    s_lshl_b32 s91, s64, 10
    v_lshrrev_b32 v9, 5, v1
    v_lshlrev_b32 v3, 8, v9
    v_bfe_u32 v10, v1, 4, 1
    s_add_u32 m0, s81, 32768
    s_nop 0
    buffer_load_dwordx4 v26, s[48:51], s100 offen lds
    v_xor_b32 v10, v10, v9
    v_lshl_add_u32 v3, v10, 5, v3
    v_bfe_u32 v9, v1, 2, 2
    v_lshl_add_u32 v3, v9, 6, v3
    v_and_b32 v9, 3, v1
    s_add_u32 m0, s81, 36864
    s_nop 0
    buffer_load_dwordx4 v26, s[52:55], s100 offen lds
    v_lshl_add_u32 v3, v9, 3, v3
    v_lshrrev_b32 v9, 4, v1
    v_lshlrev_b32 v8, 8, v9
    v_and_b32 v9, 1, v9
    s_and_b32 s69, s64, 1
    s_add_u32 s100, s16, 57344
    s_add_u32 m0, s81, 40960
    v_xor_b32 v9, s69, v9
    v_lshl_add_u32 v8, v9, 5, v8
    v_bfe_u32 v9, v1, 2, 2
    v_lshl_add_u32 v8, v9, 6, v8
    v_and_b32 v9, 3, v1
    buffer_load_dwordx4 v26, s[48:51], s100 offen lds
    s_add_u32 m0, s81, 45056
    v_lshl_add_u32 v8, v9, 3, v8
    s_lshr_b32 s69, s64, 1
    s_mul_i32 s69, s69, 14336
    v_add_u32 v8, s69, v8
    s_mul_i32 s69, s77, 448
    buffer_load_dwordx4 v26, s[52:55], s100 offen lds
    s_add_u32 s100, s16, 114688
    s_lshl_b32 s70, s78, 3
    s_add_u32 s69, s69, s70
    s_lshl_b32 s70, s64, 1
    s_add_u32 s69, s69, s70
    s_lshl_b32 s69, s69, 10
    s_add_u32 m0, s81, 49152
    s_nop 0
    buffer_load_dwordx4 v26, s[48:51], s100 offen lds
    s_add_u32 s69, s69, 4194304
    v_lshl_add_u32 v11, v1, 4, s69
    v_and_b32 v9, 31, v1
    v_lshlrev_b32 v12, 3, v9
    s_lshl_b32 s69, s77, 10
    s_add_u32 m0, s81, 53248
    s_nop 0
    buffer_load_dwordx4 v26, s[52:55], s100 offen lds
    s_add_u32 s69, s69, 65536
    v_add_u32 v12, s69, v12
    v_and_b32 v9, 31, v1
    v_lshlrev_b32 v9, 2, v9
    s_lshl_b32 s69, s78, 9
    s_add_u32 s100, s16, 172032
    s_add_u32 m0, s81, 57344
    s_lshl_b32 s70, s64, 7
    s_add_u32 s69, s69, s70
    s_add_u32 s69, s69, 81920
    v_add_u32 v13, s69, v9
    v_bfe_u32 v9, v1, 4, 1
    buffer_load_dwordx4 v26, s[48:51], s100 offen lds
    s_add_u32 m0, s81, 61440
    v_lshlrev_b32 v27, 7, v9
    v_and_b32 v9, 15, v1
    v_lshl_add_u32 v27, v9, 3, v27
    v_add_u32 v27, 86016, v27
    s_lshl_b32 s69, s64, 7
    buffer_load_dwordx4 v26, s[52:55], s100 offen lds
    s_add_u32 s100, s16, 229376
    s_add_u32 s69, s69, 86016
    v_lshl_add_u32 v33, v9, 3, s69
    s_mov_b32 s6, 0x22222222
    s_mov_b32 s7, 0x22222222
    s_mov_b32 s8, 0x44444444
    s_add_u32 m0, s81, 65536
    s_nop 0
    buffer_load_dwordx4 v26, s[48:51], s100 offen lds
    s_mov_b32 s9, 0x44444444
    s_mov_b32 s10, 0x88888888
    s_mov_b32 s11, 0x88888888
    s_mov_b32 s12, 0x00f0000f
    s_mov_b32 s13, 0xf0000f00
    s_add_u32 m0, s81, 69632
    s_nop 0
    buffer_load_dwordx4 v26, s[52:55], s100 offen lds
    v_add_u32 v34, 57344, v8
    s_add_u32 s69, s99, 0
    s_and_b32 s69, s69, 3
    s_mul_i32 s69, s69, 7168
    v_add_u32 v192, s69, v3
    s_add_u32 s100, s16, 286720
    s_sub_u32 m0, s81, 12544
    s_add_u32 s69, s99, 1
    s_and_b32 s69, s69, 3
    s_mul_i32 s69, s69, 7168
    v_add_u32 v193, s69, v3
    s_add_u32 s69, s99, 2
    buffer_load_dwordx4 v26, s[48:51], s100 offen lds
    s_sub_u32 m0, s81, 8448
    s_and_b32 s69, s69, 3
    s_mul_i32 s69, s69, 7168
    v_add_u32 v194, s69, v3
    s_add_u32 s69, s99, 3
    s_and_b32 s69, s69, 3
    buffer_load_dwordx4 v26, s[52:55], s100 offen lds
    s_add_u32 s100, s16, 344064
    s_mul_i32 s69, s69, 7168
    v_add_u32 v195, s69, v3
    s_add_u32 s69, s64, 0
    s_mul_i32 s70, s69, 37
    s_lshr_b32 s70, s70, 8
    s_sub_u32 m0, s81, 29696
    s_nop 0
    buffer_load_dwordx4 v26, s[48:51], s100 offen lds
    s_mul_i32 s71, s70, 7
    s_sub_u32 s69, s69, s71
    s_add_u32 s70, s70, s99
    s_and_b32 s70, s70, 3
    s_mul_i32 s70, s70, 7
    s_sub_u32 m0, s81, 25600
    s_nop 0
    buffer_load_dwordx4 v26, s[52:55], s100 offen lds
    s_add_u32 s0, s70, s69
    s_add_u32 s69, s64, 4
    s_mul_i32 s70, s69, 37
    s_lshr_b32 s70, s70, 8
    s_mul_i32 s71, s70, 7
    s_add_u32 s100, s17, 0
    s_sub_u32 m0, s81, 21504
    s_sub_u32 s69, s69, s71
    s_add_u32 s70, s70, s99
    s_and_b32 s70, s70, 3
    s_mul_i32 s70, s70, 7
    s_add_u32 s1, s70, s69
    buffer_load_dwordx4 v26, s[48:51], s100 offen lds
    s_sub_u32 m0, s81, 17408
    s_add_u32 s69, s64, 8
    s_mul_i32 s70, s69, 37
    s_lshr_b32 s70, s70, 8
    s_mul_i32 s71, s70, 7
    s_sub_u32 s69, s69, s71
    buffer_load_dwordx4 v26, s[52:55], s100 offen lds
    s_add_u32 s100, s17, 57344
    s_add_u32 s70, s70, s99
    s_and_b32 s70, s70, 3
    s_mul_i32 s70, s70, 7
    s_add_u32 s3, s70, s69
    s_add_u32 s69, s64, 12
    s_sub_u32 m0, s81, 87040
    s_nop 0
    buffer_load_dwordx4 v26, s[48:51], s100 offen lds
    s_mul_i32 s70, s69, 37
    s_lshr_b32 s70, s70, 8
    s_mul_i32 s71, s70, 7
    s_sub_u32 s69, s69, s71
    s_add_u32 s70, s70, s99
    s_sub_u32 m0, s81, 82944
    s_nop 0
    buffer_load_dwordx4 v26, s[52:55], s100 offen lds
    s_and_b32 s70, s70, 3
    s_mul_i32 s70, s70, 7
    s_add_u32 s4, s70, s69
    s_add_u32 s69, s64, 16
    s_mul_i32 s70, s69, 37
    s_add_u32 s100, s17, 114688
    s_sub_u32 m0, s81, 78848
    s_lshr_b32 s70, s70, 8
    s_mul_i32 s71, s70, 7
    s_sub_u32 s69, s69, s71
    s_add_u32 s70, s70, s99
    s_and_b32 s70, s70, 3
    buffer_load_dwordx4 v26, s[48:51], s100 offen lds
    s_sub_u32 m0, s81, 74752
    s_mul_i32 s70, s70, 7
    s_add_u32 s5, s70, s69
    s_add_u32 s69, s64, 20
    s_mul_i32 s70, s69, 37
    s_lshr_b32 s70, s70, 8
    buffer_load_dwordx4 v26, s[52:55], s100 offen lds
    s_add_u32 s100, s17, 172032
    s_mul_i32 s71, s70, 7
    s_sub_u32 s69, s69, s71
    s_add_u32 s70, s70, s99
    s_and_b32 s70, s70, 3
    s_mul_i32 s70, s70, 7
    s_sub_u32 m0, s81, 70656
    s_nop 0
    buffer_load_dwordx4 v26, s[48:51], s100 offen lds
    s_add_u32 s22, s70, s69
    s_add_u32 s69, s64, 24
    s_mul_i32 s70, s69, 37
    s_lshr_b32 s70, s70, 8
    s_mul_i32 s71, s70, 7
    s_sub_u32 m0, s81, 66560
    s_nop 0
    buffer_load_dwordx4 v26, s[52:55], s100 offen lds
    s_sub_u32 s69, s69, s71
    s_add_u32 s70, s70, s99
    s_and_b32 s70, s70, 3
    s_mul_i32 s70, s70, 7
    s_add_u32 s23, s70, s69
    s_add_u32 s100, s17, 229376
    s_sub_u32 m0, s81, 62464
    v_lshrrev_b32 v35, 3, v1
    v_mul_u32_u24 v196, 896, v35
    v_bfe_u32 v35, v1, 4, 1
    v_lshlrev_b32 v35, 2, v35
    v_and_b32 v175, 7, v1
    buffer_load_dwordx4 v26, s[48:51], s100 offen lds
    s_sub_u32 m0, s81, 58368
    v_xor_b32 v35, v35, v175
    v_lshl_add_u32 v196, v35, 4, v196
    s_lshl_b32 s69, s80, 7
    s_mul_i32 s70, s64, 401408
    s_add_u32 s69, s69, s70
    buffer_load_dwordx4 v26, s[52:55], s100 offen lds
    s_add_u32 s100, s17, 286720
    v_add_u32 v196, s69, v196
    v_add_u32 v197, 7168, v196
    v_lshrrev_b32 v35, 5, v1
    v_lshlrev_b32 v198, 9, v35
    v_bfe_u32 v35, v1, 2, 2
    s_sub_u32 m0, s81, 54272
    s_nop 0
    buffer_load_dwordx4 v26, s[48:51], s100 offen lds
    v_lshl_add_u32 v198, v35, 7, v198
    v_bfe_u32 v35, v1, 4, 1
    v_lshl_add_u32 v198, v35, 5, v198
    v_and_b32 v35, 3, v1
    v_lshl_add_u32 v198, v35, 3, v198
    s_sub_u32 m0, s81, 50176
    s_nop 0
    buffer_load_dwordx4 v26, s[52:55], s100 offen lds
    v_bfe_u32 v35, v1, 3, 1
    v_lshlrev_b32 v35, 6, v35
    v_xor_b32 v175, 64, v35
    v_add_u32 v199, v198, v175
    v_add_u32 v198, v198, v35
    s_add_u32 s100, s17, 344064
    s_sub_u32 m0, s81, 46080
    s_mul_i32 s18, s64, 18432
    s_add_u32 s18, s18, 87040
    s_mul_i32 s19, s64, 7168
    s_add_u32 s20, s19, 57344
    s_add_u32 s19, s19, 28672
    buffer_load_dwordx4 v26, s[48:51], s100 offen lds
    s_sub_u32 m0, s81, 41984
    v_add_u32 v200, s19, v198
    v_add_u32 v201, s19, v199
    v_add_u32 v202, s20, v198
    v_add_u32 v203, s20, v199
    v_add_u32 v198, s18, v198
    buffer_load_dwordx4 v26, s[52:55], s100 offen lds
    v_add_u32 v199, s18, v199
    s_add_u32 s70, s80, s79
    s_add_u32 s69, s70, 0
    s_and_b32 s69, s69, 3
    s_mul_i32 s24, s69, 100352
    s_mul_i32 s28, s69, 7168
    s_add_u32 s69, s70, 1
    s_and_b32 s69, s69, 3
    s_mul_i32 s25, s69, 100352
    s_mul_i32 s29, s69, 7168
    s_add_u32 s69, s70, 2
    s_and_b32 s69, s69, 3
    s_mul_i32 s26, s69, 100352
    s_mul_i32 s30, s69, 7168
    s_add_u32 s69, s70, 3
    s_and_b32 s69, s69, 3
    s_mul_i32 s27, s69, 100352
    s_mul_i32 s31, s69, 7168
    s_waitcnt vmcnt(0)
    s_cmp_lg_u32 s64, 0
    s_cbranch_scc1 Lpf_26
    v_mul_u32_u24 v35, 16, v1
    v_add_u32 v35, 16384, v35
    s_mov_b64 s[84:85], exec
    s_mov_b32 s90, 0
Lpl_27:
    buffer_load_dword v204, v35, s[40:43], 0 offen offset:0 sc1
    buffer_load_dword v205, v35, s[40:43], 0 offen offset:1024 sc1
    buffer_load_dword v206, v35, s[40:43], 0 offen offset:2048 sc1
    buffer_load_dword v207, v35, s[40:43], 0 offen offset:3072 sc1
    s_waitcnt vmcnt(0)
    v_cmp_ne_u32 vcc, s65, v204
    v_cmp_ne_u32 s[86:87], s65, v205
    s_nop 0
    s_or_b64 vcc, vcc, s[86:87]
    v_cmp_ne_u32 s[86:87], s65, v206
    s_nop 0
    s_or_b64 vcc, vcc, s[86:87]
    v_cmp_ne_u32 s[86:87], s65, v207
    s_nop 0
    s_or_b64 vcc, vcc, s[86:87]
    s_cbranch_vccz Lpd_28
    s_sleep 2
    s_add_u32 s90, s90, 1
    s_cmp_lt_u32 s90, 50000
    s_cbranch_scc1 Lpl_27
Lpd_28:
    s_mov_b64 exec, s[84:85]
Lpf_26:
    s_barrier
    ds_read_b64_tr_b16 a[176:177], v32 offset:0
    ds_read_b64_tr_b16 a[178:179], v32 offset:2048
    ds_read_b64_tr_b16 a[180:181], v32 offset:4096
    ds_read_b64_tr_b16 a[182:183], v32 offset:6144
    ds_read_b64_tr_b16 a[184:185], v32 offset:8192
    ds_read_b64_tr_b16 a[186:187], v32 offset:10240
    ds_read_b64_tr_b16 a[188:189], v32 offset:12288
    ds_read_b64_tr_b16 a[190:191], v32 offset:14336
    ds_read_b64_tr_b16 a[192:193], v32 offset:16384
    ds_read_b64_tr_b16 a[194:195], v32 offset:18432
    ds_read_b64_tr_b16 a[196:197], v32 offset:20480
    ds_read_b64_tr_b16 a[198:199], v32 offset:22528
    ds_read_b64_tr_b16 a[200:201], v32 offset:24576
    ds_read_b64_tr_b16 a[202:203], v32 offset:26624
    ds_read_b64_tr_b16 a[204:205], v32 offset:28672
    ds_read_b64_tr_b16 a[206:207], v32 offset:30720
    ds_read_b64_tr_b16 a[208:209], v32 offset:32768
    ds_read_b64_tr_b16 a[210:211], v32 offset:34816
    ds_read_b64_tr_b16 a[212:213], v32 offset:36864
    ds_read_b64_tr_b16 a[214:215], v32 offset:38912
    ds_read_b64_tr_b16 a[216:217], v32 offset:40960
    ds_read_b64_tr_b16 a[218:219], v32 offset:43008
    ds_read_b64_tr_b16 a[220:221], v32 offset:45056
    ds_read_b64_tr_b16 a[222:223], v32 offset:47104
    s_waitcnt lgkmcnt(0)
    s_barrier
    s_lshl_b32 m0, s0, 10
    s_mul_i32 s70, s0, 69632
    buffer_load_dwordx4 v2, s[40:43], s70 offen sc1 lds
    s_lshl_b32 m0, s1, 10
    s_mul_i32 s70, s1, 69632
    buffer_load_dwordx4 v2, s[40:43], s70 offen sc1 lds
    s_lshl_b32 m0, s3, 10
    s_mul_i32 s70, s3, 69632
    buffer_load_dwordx4 v2, s[40:43], s70 offen sc1 lds
    s_lshl_b32 m0, s4, 10
    s_mul_i32 s70, s4, 69632
    buffer_load_dwordx4 v2, s[40:43], s70 offen sc1 lds
    s_lshl_b32 m0, s5, 10
    s_mul_i32 s70, s5, 69632
    buffer_load_dwordx4 v2, s[40:43], s70 offen sc1 lds
    s_lshl_b32 m0, s22, 10
    s_mul_i32 s70, s22, 69632
    buffer_load_dwordx4 v2, s[40:43], s70 offen sc1 lds
    s_lshl_b32 m0, s23, 10
    s_mul_i32 s70, s23, 69632
    buffer_load_dwordx4 v2, s[40:43], s70 offen sc1 lds
    ds_read_b64_tr_b16 a[80:81], v28 offset:0
    ds_read_b64_tr_b16 a[82:83], v28 offset:2048
    ds_read_b64_tr_b16 a[84:85], v28 offset:4096
    ds_read_b64_tr_b16 a[86:87], v28 offset:6144
    ds_read_b64_tr_b16 a[88:89], v28 offset:8192
    ds_read_b64_tr_b16 a[90:91], v28 offset:10240
    ds_read_b64_tr_b16 a[92:93], v28 offset:12288
    ds_read_b64_tr_b16 a[94:95], v28 offset:14336
    ds_read_b64_tr_b16 a[96:97], v28 offset:16384
    ds_read_b64_tr_b16 a[98:99], v28 offset:18432
    ds_read_b64_tr_b16 a[100:101], v28 offset:20480
    ds_read_b64_tr_b16 a[102:103], v28 offset:22528
    ds_read_b64_tr_b16 a[104:105], v28 offset:24576
    ds_read_b64_tr_b16 a[106:107], v28 offset:26624
    ds_read_b64_tr_b16 a[108:109], v28 offset:28672
    ds_read_b64_tr_b16 a[110:111], v28 offset:30720
    ds_read_b64_tr_b16 a[112:113], v28 offset:32768
    ds_read_b64_tr_b16 a[114:115], v28 offset:34816
    ds_read_b64_tr_b16 a[116:117], v28 offset:36864
    ds_read_b64_tr_b16 a[118:119], v28 offset:38912
    ds_read_b64_tr_b16 a[120:121], v28 offset:40960
    ds_read_b64_tr_b16 a[122:123], v28 offset:43008
    ds_read_b64_tr_b16 a[124:125], v28 offset:45056
    ds_read_b64_tr_b16 a[126:127], v28 offset:47104
    ds_read_b64_tr_b16 a[128:129], v28 offset:49152
    ds_read_b64_tr_b16 a[130:131], v28 offset:51200
    ds_read_b64_tr_b16 a[132:133], v28 offset:53248
    ds_read_b64_tr_b16 a[134:135], v28 offset:55296
    ds_read_b64_tr_b16 a[136:137], v28 offset:57344
    ds_read_b64_tr_b16 a[138:139], v28 offset:59392
    ds_read_b64_tr_b16 a[140:141], v28 offset:61440
    ds_read_b64_tr_b16 a[142:143], v28 offset:63488
    ds_read_b64_tr_b16 a[144:145], v30 offset:0
    ds_read_b64_tr_b16 a[146:147], v30 offset:2048
    ds_read_b64_tr_b16 a[148:149], v30 offset:4096
    ds_read_b64_tr_b16 a[150:151], v30 offset:6144
    ds_read_b64_tr_b16 a[152:153], v29 offset:0
    ds_read_b64_tr_b16 a[154:155], v29 offset:2048
    ds_read_b64_tr_b16 a[156:157], v29 offset:4096
    ds_read_b64_tr_b16 a[158:159], v29 offset:6144
    ds_read_b64_tr_b16 a[160:161], v31 offset:0
    ds_read_b64_tr_b16 a[162:163], v31 offset:2048
    ds_read_b64_tr_b16 a[164:165], v31 offset:4096
    ds_read_b64_tr_b16 a[166:167], v31 offset:6144
    ds_read_b64_tr_b16 a[168:169], v31 offset:8192
    ds_read_b64_tr_b16 a[170:171], v31 offset:10240
    ds_read_b64_tr_b16 a[172:173], v31 offset:12288
    ds_read_b64_tr_b16 a[174:175], v31 offset:14336
    s_waitcnt lgkmcnt(0)
    s_mov_b32 s71, 7168
    buffer_load_dword v36, v13, s[40:43], 0 offen sc1
    buffer_load_dword v52, v13, s[40:43], s71 offen sc1
    v_mov_b32 v29, 0
    v_mov_b32 v205, 0
    v_mov_b32 v209, 0
    v_mov_b32 v30, 0
    v_mov_b32 v206, 0
    v_mov_b32 v210, 0
    v_mov_b32 v31, 0
    v_mov_b32 v207, 0
    v_mov_b32 v211, 0
    s_waitcnt vmcnt(6)
    s_waitcnt lgkmcnt(0)
    s_barrier
    ds_read_b64_tr_b16 v[68:69], v192 offset:0
    ds_read_b64_tr_b16 v[70:71], v192 offset:512
    ds_read_b64_tr_b16 v[72:73], v192 offset:1024
    ds_read_b64_tr_b16 v[74:75], v192 offset:1536
    ds_read_b64_tr_b16 v[76:77], v192 offset:2048
    ds_read_b64_tr_b16 v[78:79], v192 offset:2560
    ds_read_b64_tr_b16 v[80:81], v192 offset:3072
    ds_read_b64_tr_b16 v[82:83], v192 offset:3584
    s_waitcnt lgkmcnt(6)
    v_mfma_f32_32x32x16_bf16 v[108:123], a[0:3], v[68:71], 0
    ds_read_b64_tr_b16 v[84:85], v192 offset:4096
    s_add_u32 m0, s91, 28672
    v_mfma_f32_32x32x16_bf16 v[124:139], a[4:7], v[68:71], 0
    ds_read_b64_tr_b16 v[86:87], v192 offset:4608
    s_add_u32 s70, s74, 64
    buffer_load_dwordx4 v2, s[40:43], s70 offen sc1 lds
    s_waitcnt lgkmcnt(6)
    v_mfma_f32_32x32x16_bf16 v[108:123], a[8:11], v[72:75], v[108:123]
    ds_read_b64_tr_b16 v[88:89], v192 offset:5120
    s_add_u32 m0, s91, 32768
    s_add_u32 s70, s74, 278592
    v_mfma_f32_32x32x16_bf16 v[124:139], a[12:15], v[72:75], v[124:139]
    ds_read_b64_tr_b16 v[90:91], v192 offset:5632
    buffer_load_dwordx4 v2, s[40:43], s70 offen sc1 lds
    s_add_u32 m0, s91, 36864
    s_waitcnt lgkmcnt(6)
    v_mfma_f32_32x32x16_bf16 v[108:123], a[16:19], v[76:79], v[108:123]
    ds_read_b64_tr_b16 v[68:69], v192 offset:6144
    s_add_u32 s70, s74, 557120
    v_mfma_f32_32x32x16_bf16 v[124:139], a[20:23], v[76:79], v[124:139]
    ds_read_b64_tr_b16 v[70:71], v192 offset:6656
    buffer_load_dwordx4 v2, s[40:43], s70 offen sc1 lds
    s_add_u32 m0, s91, 40960
    s_waitcnt lgkmcnt(6)
    v_mfma_f32_32x32x16_bf16 v[108:123], a[24:27], v[80:83], v[108:123]
    ds_read_b64_tr_b16 v[72:73], v193 offset:0
    s_add_u32 s70, s74, 835648
    buffer_load_dwordx4 v2, s[40:43], s70 offen sc1 lds
    v_mfma_f32_32x32x16_bf16 v[124:139], a[28:31], v[80:83], v[124:139]
    ds_read_b64_tr_b16 v[74:75], v193 offset:512
    s_add_u32 m0, s91, 45056
    s_add_u32 s70, s74, 1114176
    s_waitcnt lgkmcnt(6)
    v_mfma_f32_32x32x16_bf16 v[108:123], a[32:35], v[84:87], v[108:123]
    ds_read_b64_tr_b16 v[76:77], v193 offset:1024
    buffer_load_dwordx4 v2, s[40:43], s70 offen sc1 lds
    v_mfma_f32_32x32x16_bf16 v[124:139], a[36:39], v[84:87], v[124:139]
    ds_read_b64_tr_b16 v[78:79], v193 offset:1536
    s_add_u32 m0, s91, 49152
    s_add_u32 s70, s74, 1392704
    s_waitcnt lgkmcnt(6)
    v_mfma_f32_32x32x16_bf16 v[108:123], a[40:43], v[88:91], v[108:123]
    ds_read_b64_tr_b16 v[80:81], v193 offset:2048
    buffer_load_dwordx4 v2, s[40:43], s70 offen sc1 lds
    s_add_u32 m0, s91, 53248
    v_mfma_f32_32x32x16_bf16 v[124:139], a[44:47], v[88:91], v[124:139]
    ds_read_b64_tr_b16 v[82:83], v193 offset:2560
    s_add_u32 s70, s74, 1671232
    buffer_load_dwordx4 v2, s[40:43], s70 offen sc1 lds
    s_waitcnt lgkmcnt(6)
    v_mfma_f32_32x32x16_bf16 v[108:123], a[48:51], v[68:71], v[108:123]
    ds_read_b64_tr_b16 v[84:85], v193 offset:3072
    v_mfma_f32_32x32x16_bf16 v[124:139], a[52:55], v[68:71], v[124:139]
    ds_read_b64_tr_b16 v[86:87], v193 offset:3584
    s_waitcnt lgkmcnt(6)
    v_mfma_f32_32x32x16_bf16 v[108:123], a[56:59], v[72:75], v[108:123]
    ds_read_b64_tr_b16 v[88:89], v193 offset:4096
    v_mfma_f32_32x32x16_bf16 v[124:139], a[60:63], v[72:75], v[124:139]
    ds_read_b64_tr_b16 v[90:91], v193 offset:4608
    s_waitcnt vmcnt(9)
    s_barrier
    s_waitcnt lgkmcnt(6)
    v_mfma_f32_32x32x16_bf16 v[108:123], a[64:67], v[76:79], v[108:123]
    ds_read_b64_tr_b16 v[68:69], v193 offset:5120
    ds_read_b64_tr_b16 v[92:93], v8 offset:0
    ds_read_b64_tr_b16 v[94:95], v8 offset:1024
    v_mfma_f32_32x32x16_bf16 v[124:139], a[68:71], v[76:79], v[124:139]
    ds_read_b64_tr_b16 v[70:71], v193 offset:5632
    ds_read_b64_tr_b16 v[96:97], v8 offset:2048
    ds_read_b64_tr_b16 v[98:99], v8 offset:3072
    s_waitcnt lgkmcnt(10)
    v_mfma_f32_32x32x16_bf16 v[108:123], a[72:75], v[80:83], v[108:123]
    ds_read_b64_tr_b16 v[72:73], v193 offset:6144
    s_add_u32 m0, s91, 57344
    v_mfma_f32_32x32x16_bf16 v[124:139], a[76:79], v[80:83], v[124:139]
    ds_read_b64_tr_b16 v[74:75], v193 offset:6656
    s_add_u32 s70, s74, 128
    s_waitcnt lgkmcnt(10)
    v_mfma_f32_32x32x16_bf16 v[108:123], a[80:83], v[84:87], v[108:123]
    ds_read_b64_tr_b16 v[76:77], v194 offset:0
    v_mfma_f32_32x32x16_bf16 v[124:139], a[84:87], v[84:87], v[124:139]
    ds_read_b64_tr_b16 v[78:79], v194 offset:512
    s_waitcnt vmcnt(7)
    s_waitcnt lgkmcnt(7)
    v_mfma_f32_16x16x32_bf16 v[100:103], v[92:95], v[92:95], 0
    buffer_load_dwordx4 v2, s[40:43], s70 offen sc1 lds
    v_mfma_f32_16x16x32_bf16 v[104:107], v[4:7], v[92:95], 0
    ds_read_b64_tr_b16 v[92:93], v8 offset:4096
    ds_read_b64_tr_b16 v[94:95], v8 offset:5120
    v_mfma_f32_32x32x16_bf16 v[108:123], a[88:91], v[88:91], v[108:123]
    ds_read_b64_tr_b16 v[80:81], v194 offset:1024
    s_add_u32 m0, s91, 61440
    v_mfma_f32_32x32x16_bf16 v[124:139], a[92:95], v[88:91], v[124:139]
    ds_read_b64_tr_b16 v[82:83], v194 offset:1536
    s_waitcnt lgkmcnt(8)
    v_mfma_f32_16x16x32_bf16 v[100:103], v[96:99], v[96:99], v[100:103]
    v_cvt_pk_bf16_f32 v204, v36, v36
    v_mfma_f32_16x16x32_bf16 v[104:107], v[4:7], v[96:99], v[104:107]
    ds_read_b64_tr_b16 v[96:97], v8 offset:6144
    ds_read_b64_tr_b16 v[98:99], v8 offset:7168
    v_mfma_f32_32x32x16_bf16 v[108:123], a[96:99], v[68:71], v[108:123]
    ds_read_b64_tr_b16 v[84:85], v194 offset:2048
    s_add_u32 s70, s74, 278656
    v_mfma_f32_32x32x16_bf16 v[124:139], a[100:103], v[68:71], v[124:139]
    ds_read_b64_tr_b16 v[86:87], v194 offset:2560
    s_waitcnt lgkmcnt(10)
    v_mfma_f32_32x32x16_bf16 v[108:123], a[104:107], v[72:75], v[108:123]
    ds_read_b64_tr_b16 v[88:89], v194 offset:3072
    v_lshlrev_b32 v204, 16, v204
    v_mfma_f32_32x32x16_bf16 v[124:139], a[108:111], v[72:75], v[124:139]
    ds_read_b64_tr_b16 v[90:91], v194 offset:3584
    buffer_load_dwordx4 v2, s[40:43], s70 offen sc1 lds
    s_waitcnt lgkmcnt(8)
    v_mfma_f32_16x16x32_bf16 v[100:103], v[92:95], v[92:95], v[100:103]
    v_mfma_f32_16x16x32_bf16 v[104:107], v[4:7], v[92:95], v[104:107]
    ds_read_b64_tr_b16 v[92:93], v8 offset:8192
    ds_read_b64_tr_b16 v[94:95], v8 offset:9216
    v_mfma_f32_32x32x16_bf16 v[108:123], a[112:115], v[76:79], v[108:123]
    ds_read_b64_tr_b16 v[68:69], v194 offset:4096
    s_add_u32 m0, s91, 65536
    v_mfma_f32_32x32x16_bf16 v[124:139], a[116:119], v[76:79], v[124:139]
    ds_read_b64_tr_b16 v[70:71], v194 offset:4608
    v_sub_f32 v37, v36, v204
    s_waitcnt lgkmcnt(8)
    v_mfma_f32_16x16x32_bf16 v[100:103], v[96:99], v[96:99], v[100:103]
    v_mfma_f32_16x16x32_bf16 v[104:107], v[4:7], v[96:99], v[104:107]
    ds_read_b64_tr_b16 v[96:97], v8 offset:10240
    ds_read_b64_tr_b16 v[98:99], v8 offset:11264
    v_mfma_f32_32x32x16_bf16 v[108:123], a[120:123], v[80:83], v[108:123]
    ds_read_b64_tr_b16 v[72:73], v194 offset:5120
    s_add_u32 s70, s74, 557184
    v_mfma_f32_32x32x16_bf16 v[124:139], a[124:127], v[80:83], v[124:139]
    ds_read_b64_tr_b16 v[74:75], v194 offset:5632
    buffer_load_dwordx4 v2, s[40:43], s70 offen sc1 lds
    s_waitcnt lgkmcnt(10)
    v_mfma_f32_32x32x16_bf16 v[108:123], a[128:131], v[84:87], v[108:123]
    ds_read_b64_tr_b16 v[76:77], v194 offset:6144
    v_cvt_pk_bf16_f32 v204, v36, v37
    v_mfma_f32_32x32x16_bf16 v[124:139], a[132:135], v[84:87], v[124:139]
    ds_read_b64_tr_b16 v[78:79], v194 offset:6656
    s_add_u32 m0, s91, 69632
    s_waitcnt lgkmcnt(8)
    v_mfma_f32_16x16x32_bf16 v[100:103], v[92:95], v[92:95], v[100:103]
    v_mfma_f32_16x16x32_bf16 v[104:107], v[4:7], v[92:95], v[104:107]
    ds_read_b64_tr_b16 v[92:93], v8 offset:12288
    ds_read_b64_tr_b16 v[94:95], v8 offset:13312
    v_mfma_f32_32x32x16_bf16 v[108:123], a[136:139], v[88:91], v[108:123]
    ds_read_b64_tr_b16 v[80:81], v195 offset:0
    v_cmp_gt_u32 vcc, 32, v1
    v_mfma_f32_32x32x16_bf16 v[124:139], a[140:143], v[88:91], v[124:139]
    ds_read_b64_tr_b16 v[82:83], v195 offset:512
    s_add_u32 s70, s74, 835712
    s_waitcnt lgkmcnt(8)
    v_mfma_f32_16x16x32_bf16 v[100:103], v[96:99], v[96:99], v[100:103]
    v_mfma_f32_16x16x32_bf16 v[104:107], v[4:7], v[96:99], v[104:107]
    v_mfma_f32_32x32x16_bf16 v[108:123], a[144:147], v[68:71], v[108:123]
    ds_read_b64_tr_b16 v[84:85], v195 offset:1024
    buffer_load_dwordx4 v2, s[40:43], s70 offen sc1 lds
    v_mfma_f32_32x32x16_bf16 v[124:139], a[148:151], v[68:71], v[124:139]
    ds_read_b64_tr_b16 v[86:87], v195 offset:1536
    v_cndmask_b32 v204, 0, v204, vcc
    s_waitcnt lgkmcnt(8)
    v_mfma_f32_32x32x16_bf16 v[108:123], a[152:155], v[72:75], v[108:123]
    ds_read_b64_tr_b16 v[88:89], v195 offset:2048
    s_add_u32 m0, s91, 73728
    v_mfma_f32_32x32x16_bf16 v[124:139], a[156:159], v[72:75], v[124:139]
    ds_read_b64_tr_b16 v[90:91], v195 offset:2560
    v_cvt_pk_bf16_f32 v208, v52, v52
    s_waitcnt lgkmcnt(6)
    v_mfma_f32_16x16x32_bf16 v[100:103], v[92:95], v[92:95], v[100:103]
    v_mfma_f32_16x16x32_bf16 v[104:107], v[4:7], v[92:95], v[104:107]
    v_mfma_f32_32x32x16_bf16 v[108:123], a[160:163], v[76:79], v[108:123]
    ds_read_b64_tr_b16 v[68:69], v195 offset:3072
    s_add_u32 s70, s74, 1114240
    v_mfma_f32_32x32x16_bf16 v[124:139], a[164:167], v[76:79], v[124:139]
    ds_read_b64_tr_b16 v[70:71], v195 offset:3584
    buffer_load_dwordx4 v2, s[40:43], s70 offen sc1 lds
    s_waitcnt lgkmcnt(6)
    v_mfma_f32_32x32x16_bf16 v[108:123], a[168:171], v[80:83], v[108:123]
    ds_read_b64_tr_b16 v[72:73], v195 offset:4096
    v_lshlrev_b32 v208, 16, v208
    v_mfma_f32_32x32x16_bf16 v[124:139], a[172:175], v[80:83], v[124:139]
    ds_read_b64_tr_b16 v[74:75], v195 offset:4608
    v_cndmask_b32 v100, v100, v101, s[6:7]
    v_cndmask_b32 v100, v100, v102, s[8:9]
    v_cndmask_b32 v105, v100, v103, s[10:11]
    s_mov_b64 exec, s[12:13]
    ds_write_b64 v33, v[104:105] offset:0
    s_mov_b64 exec, -1
    s_waitcnt vmcnt(5)
    s_waitcnt lgkmcnt(0)
    s_barrier
    v_mfma_f32_32x32x16_bf16 v[108:123], a[176:179], v[84:87], v[108:123]
    ds_read_b64_tr_b16 v[76:77], v195 offset:5120
    s_add_u32 m0, s91, 77824
    v_mfma_f32_32x32x16_bf16 v[124:139], a[180:183], v[84:87], v[124:139]
    ds_read_b64_tr_b16 v[78:79], v195 offset:5632
    v_mfma_f32_32x32x16_bf16 v[108:123], a[184:187], v[88:91], v[108:123]
    ds_read_b64_tr_b16 v[80:81], v195 offset:6144
    s_add_u32 s70, s74, 1392768
    v_mfma_f32_32x32x16_bf16 v[124:139], a[188:191], v[88:91], v[124:139]
    ds_read_b64_tr_b16 v[82:83], v195 offset:6656
    v_sub_f32 v53, v52, v208
    v_mfma_f32_32x32x16_bf16 v[108:123], a[192:195], v[68:71], v[108:123]
    ds_read_b64_tr_b16 v[84:85], v192 offset:28672
    buffer_load_dwordx4 v2, s[40:43], s70 offen sc1 lds
    v_mfma_f32_32x32x16_bf16 v[124:139], a[196:199], v[68:71], v[124:139]
    ds_read_b64_tr_b16 v[86:87], v192 offset:29184
    v_cvt_pk_bf16_f32 v208, v52, v53
    v_mfma_f32_32x32x16_bf16 v[108:123], a[200:203], v[72:75], v[108:123]
    ds_read_b64_tr_b16 v[88:89], v192 offset:29696
    s_add_u32 m0, s91, 81920
    v_mfma_f32_32x32x16_bf16 v[124:139], a[204:207], v[72:75], v[124:139]
    ds_read_b64_tr_b16 v[90:91], v192 offset:30208
    s_waitcnt lgkmcnt(6)
    v_mfma_f32_32x32x16_bf16 v[108:123], a[208:211], v[76:79], v[108:123]
    ds_read_b64_tr_b16 v[68:69], v192 offset:30720
    s_add_u32 s70, s74, 1671296
    v_mfma_f32_32x32x16_bf16 v[124:139], a[212:215], v[76:79], v[124:139]
    ds_read_b64_tr_b16 v[70:71], v192 offset:31232
    v_cmp_gt_u32 vcc, 32, v1
    s_waitcnt lgkmcnt(6)
    v_mfma_f32_32x32x16_bf16 v[108:123], a[216:219], v[80:83], v[108:123]
    ds_read_b64_tr_b16 v[72:73], v192 offset:31744
    buffer_load_dwordx4 v2, s[40:43], s70 offen sc1 lds
    v_mfma_f32_32x32x16_bf16 v[124:139], a[220:223], v[80:83], v[124:139]
    ds_read_b64_tr_b16 v[74:75], v192 offset:32256
    v_cndmask_b32 v208, 0, v208, vcc
    s_waitcnt lgkmcnt(6)
    v_mfma_f32_32x32x16_bf16 v[140:155], a[0:3], v[84:87], 0
    ds_read_b64_tr_b16 v[76:77], v192 offset:32768
    ds_read_b64 v[20:21], v27 offset:0
    ds_read_b64 v[22:23], v27 offset:256
    s_mov_b32 s73, 0
    s_waitcnt lgkmcnt(0)
    v_add_f32 v20, v20, v22
    v_mfma_f32_32x32x16_bf16 v[156:171], a[4:7], v[84:87], 0
    ds_read_b64_tr_b16 v[78:79], v192 offset:33280
    v_add_f32 v21, v21, v23
    v_mul_f32 v20, 0x3b124925, v20
    v_mul_f32 v21, 0x3b124925, v21
    v_mfma_f32_32x32x16_bf16 v[140:155], a[8:11], v[88:91], v[140:155]
    ds_read_b64_tr_b16 v[80:81], v192 offset:33792
    v_fma_f32 v21, -v20, v20, v21
    v_max_f32 v21, 0, v21
    v_cvt_pk_bf16_f32 v22, v20, v20
    v_lshlrev_b32 v22, 16, v22
    v_mfma_f32_32x32x16_bf16 v[156:171], a[12:15], v[88:91], v[156:171]
    ds_read_b64_tr_b16 v[82:83], v192 offset:34304
    v_cvt_pk_bf16_f32 v24, v21, v21
    v_lshlrev_b32 v24, 16, v24
    s_barrier
    v_mfma_f32_32x32x16_bf16 v[140:155], a[16:19], v[68:71], v[140:155]
    ds_read_b64_tr_b16 v[84:85], v192 offset:34816
    v_add_f32 v24, 0x3727c5ac, v24
    v_cvt_pk_bf16_f32 v24, v24, v24
    v_lshlrev_b32 v24, 16, v24
    v_mfma_f32_32x32x16_bf16 v[156:171], a[20:23], v[68:71], v[156:171]
    ds_read_b64_tr_b16 v[86:87], v192 offset:35328
    v_sqrt_f32 v24, v24
    s_nop 0
    v_cvt_pk_bf16_f32 v23, v24, v24
    v_lshlrev_b32 v23, 16, v23
    v_mfma_f32_32x32x16_bf16 v[140:155], a[24:27], v[72:75], v[140:155]
    ds_read_b64_tr_b16 v[88:89], v193 offset:28672
    v_cvt_pk_bf16_f32 v28, -v22, -v22
    v_rcp_f32 v24, v23
    v_mul_f32 v174, v23, v23
    v_mul_f32 v173, 0xbfb8aa3b, v24
    v_mfma_f32_32x32x16_bf16 v[156:171], a[28:31], v[72:75], v[156:171]
    ds_read_b64_tr_b16 v[90:91], v193 offset:29184
    s_add_u32 m0, s91, 0
    v_mfma_f32_32x32x16_bf16 v[108:123], v[204:207], v[28:31], v[108:123]
    s_add_u32 s70, s74, 192
    buffer_load_dwordx4 v2, s[40:43], s70 offen sc1 lds
    v_mfma_f32_32x32x16_bf16 v[124:139], v[208:211], v[28:31], v[124:139]
    s_add_u32 m0, s91, 4096
    s_waitcnt lgkmcnt(6)
    v_mfma_f32_32x32x16_bf16 v[140:155], a[32:35], v[76:79], v[140:155]
    ds_read_b64_tr_b16 v[68:69], v193 offset:29696
    s_add_u32 s70, s74, 278720
    v_mfma_f32_32x32x16_bf16 v[156:171], a[36:39], v[76:79], v[156:171]
    ds_read_b64_tr_b16 v[70:71], v193 offset:30208
    buffer_load_dwordx4 v2, s[40:43], s70 offen sc1 lds
    s_waitcnt lgkmcnt(6)
    v_mfma_f32_32x32x16_bf16 v[140:155], a[40:43], v[80:83], v[140:155]
    ds_read_b64_tr_b16 v[72:73], v193 offset:30720
    s_add_u32 m0, s91, 8192
    v_mul_f32 v176, v173, v108
    v_mul_f32 v177, v173, v109
    v_mul_f32 v178, v173, v110
    v_mfma_f32_32x32x16_bf16 v[156:171], a[44:47], v[80:83], v[156:171]
    ds_read_b64_tr_b16 v[74:75], v193 offset:31232
    s_add_u32 s70, s74, 557248
    v_mul_f32 v179, v173, v111
    v_mul_f32 v108, v108, v124
    v_mul_f32 v109, v109, v125
    s_waitcnt lgkmcnt(6)
    v_mfma_f32_32x32x16_bf16 v[140:155], a[48:51], v[84:87], v[140:155]
    ds_read_b64_tr_b16 v[76:77], v193 offset:31744
    buffer_load_dwordx4 v2, s[40:43], s70 offen sc1 lds
    v_mul_f32 v110, v110, v126
    v_mul_f32 v111, v111, v127
    v_exp_f32 v176, v176
    v_mfma_f32_32x32x16_bf16 v[156:171], a[52:55], v[84:87], v[156:171]
    ds_read_b64_tr_b16 v[78:79], v193 offset:32256
    s_add_u32 m0, s91, 12288
    v_exp_f32 v177, v177
    s_waitcnt lgkmcnt(6)
    v_mfma_f32_32x32x16_bf16 v[140:155], a[56:59], v[88:91], v[140:155]
    ds_read_b64_tr_b16 v[80:81], v193 offset:32768
    s_add_u32 s70, s74, 835776
    v_exp_f32 v178, v178
    v_exp_f32 v179, v179
    v_mfma_f32_32x32x16_bf16 v[156:171], a[60:63], v[88:91], v[156:171]
    ds_read_b64_tr_b16 v[82:83], v193 offset:33280
    buffer_load_dwordx4 v2, s[40:43], s70 offen sc1 lds
    v_fma_f32 v176, v176, v174, v174
    v_fma_f32 v177, v177, v174, v174
    v_fma_f32 v178, v178, v174, v174
    s_waitcnt lgkmcnt(6)
    v_mfma_f32_32x32x16_bf16 v[140:155], a[64:67], v[68:71], v[140:155]
    ds_read_b64_tr_b16 v[84:85], v193 offset:33792
    s_add_u32 m0, s91, 16384
    v_fma_f32 v179, v179, v174, v174
    v_rcp_f32 v176, v176
    v_mfma_f32_32x32x16_bf16 v[156:171], a[68:71], v[68:71], v[156:171]
    ds_read_b64_tr_b16 v[86:87], v193 offset:34304
    s_add_u32 s70, s74, 1114304
    v_rcp_f32 v177, v177
    v_rcp_f32 v178, v178
    s_waitcnt lgkmcnt(6)
    v_mfma_f32_32x32x16_bf16 v[140:155], a[72:75], v[72:75], v[140:155]
    ds_read_b64_tr_b16 v[88:89], v193 offset:34816
    buffer_load_dwordx4 v2, s[40:43], s70 offen sc1 lds
    s_add_u32 m0, s91, 20480
    v_rcp_f32 v179, v179
    v_mfma_f32_32x32x16_bf16 v[156:171], a[76:79], v[72:75], v[156:171]
    ds_read_b64_tr_b16 v[90:91], v193 offset:35328
    v_mul_f32 v108, v108, v176
    v_mul_f32 v109, v109, v177
    v_mul_f32 v110, v110, v178
    v_mul_f32 v111, v111, v179
    s_waitcnt lgkmcnt(6)
    v_mfma_f32_32x32x16_bf16 v[140:155], a[80:83], v[76:79], v[140:155]
    ds_read_b64_tr_b16 v[68:69], v194 offset:28672
    s_add_u32 s70, s74, 1392832
    buffer_load_dwordx4 v2, s[40:43], s70 offen sc1 lds
    v_cvt_pk_bf16_f32 v184, v108, v109
    v_cvt_pk_bf16_f32 v185, v110, v111
    v_mul_f32 v180, v173, v112
    v_mfma_f32_32x32x16_bf16 v[156:171], a[84:87], v[76:79], v[156:171]
    ds_read_b64_tr_b16 v[70:71], v194 offset:29184
    v_mul_f32 v181, v173, v113
    v_mul_f32 v182, v173, v114
    v_mul_f32 v183, v173, v115
    v_mul_f32 v112, v112, v128
    s_waitcnt lgkmcnt(6)
    v_mfma_f32_32x32x16_bf16 v[140:155], a[88:91], v[80:83], v[140:155]
    ds_read_b64_tr_b16 v[72:73], v194 offset:29696
    s_add_u32 m0, s91, 24576
    s_add_u32 s70, s74, 1671360
    v_mul_f32 v113, v113, v129
    v_mul_f32 v114, v114, v130
    v_mfma_f32_32x32x16_bf16 v[156:171], a[92:95], v[80:83], v[156:171]
    ds_read_b64_tr_b16 v[74:75], v194 offset:30208
    buffer_load_dwordx4 v2, s[40:43], s70 offen sc1 lds
    v_mul_f32 v115, v115, v131
    v_exp_f32 v180, v180
    s_waitcnt lgkmcnt(6)
    v_mfma_f32_32x32x16_bf16 v[140:155], a[96:99], v[84:87], v[140:155]
    ds_read_b64_tr_b16 v[76:77], v194 offset:30720
    v_exp_f32 v181, v181
    v_exp_f32 v182, v182
    v_mfma_f32_32x32x16_bf16 v[156:171], a[100:103], v[84:87], v[156:171]
    ds_read_b64_tr_b16 v[78:79], v194 offset:31232
    buffer_load_dwordx2 v[14:15], v12, s[40:43], 0 offen offset:256 sc1
    buffer_load_dwordx2 v[16:17], v12, s[40:43], 0 offen offset:512 sc1
    buffer_load_dwordx2 v[18:19], v12, s[40:43], 0 offen offset:768 sc1
    s_add_u32 s100, s24, 0
    s_waitcnt lgkmcnt(6)
    v_mfma_f32_32x32x16_bf16 v[140:155], a[104:107], v[88:91], v[140:155]
    ds_read_b64_tr_b16 v[80:81], v194 offset:31744
    s_add_u32 m0, s18, 0
    v_exp_f32 v183, v183
    v_fma_f32 v180, v180, v174, v174
    v_fma_f32 v181, v181, v174, v174
    v_fma_f32 v182, v182, v174, v174
    v_mfma_f32_32x32x16_bf16 v[156:171], a[108:111], v[88:91], v[156:171]
    ds_read_b64_tr_b16 v[82:83], v194 offset:32256
    v_fma_f32 v183, v183, v174, v174
    v_rcp_f32 v180, v180
    s_waitcnt lgkmcnt(6)
    v_mfma_f32_32x32x16_bf16 v[140:155], a[112:115], v[68:71], v[140:155]
    ds_read_b64_tr_b16 v[84:85], v194 offset:32768
    buffer_load_dwordx4 v196, s[56:59], s100 offen lds
    v_rcp_f32 v181, v181
    v_rcp_f32 v182, v182
    v_mfma_f32_32x32x16_bf16 v[156:171], a[116:119], v[68:71], v[156:171]
    ds_read_b64_tr_b16 v[86:87], v194 offset:33280
    s_add_u32 m0, s18, 1024
    v_rcp_f32 v183, v183
    v_mul_f32 v112, v112, v180
    s_waitcnt lgkmcnt(6)
    v_mfma_f32_32x32x16_bf16 v[140:155], a[120:123], v[72:75], v[140:155]
    ds_read_b64_tr_b16 v[88:89], v194 offset:33792
    buffer_load_dwordx4 v197, s[56:59], s100 offen lds
    v_mul_f32 v113, v113, v181
    v_mul_f32 v114, v114, v182
    v_mul_f32 v115, v115, v183
    v_cvt_pk_bf16_f32 v186, v112, v113
    v_mfma_f32_32x32x16_bf16 v[156:171], a[124:127], v[72:75], v[156:171]
    ds_read_b64_tr_b16 v[90:91], v194 offset:34304
    s_add_u32 s100, s24, 14336
    v_cvt_pk_bf16_f32 v187, v114, v115
    v_mul_f32 v176, v173, v116
    v_mul_f32 v177, v173, v117
    s_waitcnt lgkmcnt(6)
    v_mfma_f32_32x32x16_bf16 v[140:155], a[128:131], v[76:79], v[140:155]
    ds_read_b64_tr_b16 v[68:69], v194 offset:34816
    s_add_u32 m0, s18, 2048
    v_mul_f32 v178, v173, v118
    v_mul_f32 v179, v173, v119
    v_mul_f32 v116, v116, v132
    v_mul_f32 v117, v117, v133
    v_mfma_f32_32x32x16_bf16 v[156:171], a[132:135], v[76:79], v[156:171]
    ds_read_b64_tr_b16 v[70:71], v194 offset:35328
    buffer_load_dwordx4 v196, s[56:59], s100 offen lds
    v_mul_f32 v118, v118, v134
    s_waitcnt lgkmcnt(6)
    v_mfma_f32_32x32x16_bf16 v[140:155], a[136:139], v[80:83], v[140:155]
    ds_read_b64_tr_b16 v[72:73], v195 offset:28672
    s_add_u32 m0, s18, 3072
    v_mfma_f32_32x32x16_bf16 v[156:171], a[140:143], v[80:83], v[156:171]
    ds_read_b64_tr_b16 v[74:75], v195 offset:29184
    buffer_store_dwordx4 v[184:187], v11, s[40:43], s73 offen offset:0 sc1
    v_mul_f32 v119, v119, v135
    v_exp_f32 v176, v176
    s_waitcnt lgkmcnt(6)
    v_mfma_f32_32x32x16_bf16 v[140:155], a[144:147], v[84:87], v[140:155]
    ds_read_b64_tr_b16 v[76:77], v195 offset:29696
    buffer_load_dwordx4 v197, s[56:59], s100 offen lds
    v_exp_f32 v177, v177
    v_exp_f32 v178, v178
    v_mfma_f32_32x32x16_bf16 v[156:171], a[148:151], v[84:87], v[156:171]
    ds_read_b64_tr_b16 v[78:79], v195 offset:30208
    s_add_u32 s100, s24, 28672
    v_exp_f32 v179, v179
    s_waitcnt lgkmcnt(6)
    v_mfma_f32_32x32x16_bf16 v[140:155], a[152:155], v[88:91], v[140:155]
    ds_read_b64_tr_b16 v[80:81], v195 offset:30720
    s_add_u32 m0, s18, 4096
    v_fma_f32 v176, v176, v174, v174
    v_fma_f32 v177, v177, v174, v174
    v_fma_f32 v178, v178, v174, v174
    v_fma_f32 v179, v179, v174, v174
    v_mfma_f32_32x32x16_bf16 v[156:171], a[156:159], v[88:91], v[156:171]
    ds_read_b64_tr_b16 v[82:83], v195 offset:31232
    buffer_load_dwordx4 v196, s[56:59], s100 offen lds
    v_rcp_f32 v176, v176
    s_waitcnt lgkmcnt(6)
    v_mfma_f32_32x32x16_bf16 v[140:155], a[160:163], v[68:71], v[140:155]
    ds_read_b64_tr_b16 v[84:85], v195 offset:31744
    s_add_u32 m0, s18, 5120
    v_rcp_f32 v177, v177
    v_rcp_f32 v178, v178
    v_mfma_f32_32x32x16_bf16 v[156:171], a[164:167], v[68:71], v[156:171]
    ds_read_b64_tr_b16 v[86:87], v195 offset:32256
    buffer_load_dwordx4 v197, s[56:59], s100 offen lds
    v_rcp_f32 v179, v179
    v_mul_f32 v116, v116, v176
    s_waitcnt lgkmcnt(6)
    v_mfma_f32_32x32x16_bf16 v[140:155], a[168:171], v[72:75], v[140:155]
    ds_read_b64_tr_b16 v[88:89], v195 offset:32768
    v_mul_f32 v117, v117, v177
    v_mul_f32 v118, v118, v178
    v_mul_f32 v119, v119, v179
    v_cvt_pk_bf16_f32 v188, v116, v117
    v_cvt_pk_bf16_f32 v189, v118, v119
    v_mfma_f32_32x32x16_bf16 v[156:171], a[172:175], v[72:75], v[156:171]
    ds_read_b64_tr_b16 v[90:91], v195 offset:33280
    s_add_u32 s100, s24, 43008
    v_mul_f32 v180, v173, v120
    s_waitcnt vmcnt(17)
    s_barrier
    s_waitcnt lgkmcnt(6)
    v_mfma_f32_32x32x16_bf16 v[140:155], a[176:179], v[76:79], v[140:155]
    ds_read_b64_tr_b16 v[68:69], v195 offset:33792
    s_add_u32 m0, s18, 6144
    v_mul_f32 v181, v173, v121
    v_mul_f32 v182, v173, v122
    v_mul_f32 v183, v173, v123
    v_mul_f32 v120, v120, v136
    v_mfma_f32_32x32x16_bf16 v[156:171], a[180:183], v[76:79], v[156:171]
    ds_read_b64_tr_b16 v[70:71], v195 offset:34304
    buffer_load_dwordx4 v196, s[56:59], s100 offen lds
    v_mul_f32 v121, v121, v137
    v_mul_f32 v122, v122, v138
    s_waitcnt lgkmcnt(6)
    v_mfma_f32_32x32x16_bf16 v[140:155], a[184:187], v[80:83], v[140:155]
    ds_read_b64_tr_b16 v[72:73], v195 offset:34816
    s_add_u32 m0, s18, 7168
    v_mul_f32 v123, v123, v139
    v_exp_f32 v180, v180
    v_mfma_f32_32x32x16_bf16 v[156:171], a[188:191], v[80:83], v[156:171]
    ds_read_b64_tr_b16 v[74:75], v195 offset:35328
    v_exp_f32 v181, v181
    v_exp_f32 v182, v182
    s_waitcnt lgkmcnt(6)
    v_mfma_f32_32x32x16_bf16 v[140:155], a[192:195], v[84:87], v[140:155]
    ds_read_b64_tr_b16 v[76:77], v192 offset:57344
    buffer_load_dwordx4 v197, s[56:59], s100 offen lds
    v_exp_f32 v183, v183
    v_fma_f32 v180, v180, v174, v174
    v_fma_f32 v181, v181, v174, v174
    v_fma_f32 v182, v182, v174, v174
    v_mfma_f32_32x32x16_bf16 v[156:171], a[196:199], v[84:87], v[156:171]
    ds_read_b64_tr_b16 v[78:79], v192 offset:57856
    s_add_u32 s100, s24, 57344
    v_fma_f32 v183, v183, v174, v174
    s_waitcnt lgkmcnt(6)
    v_mfma_f32_32x32x16_bf16 v[140:155], a[200:203], v[88:91], v[140:155]
    ds_read_b64_tr_b16 v[80:81], v192 offset:58368
    s_add_u32 m0, s18, 8192
    v_rcp_f32 v180, v180
    v_rcp_f32 v181, v181
    v_mfma_f32_32x32x16_bf16 v[156:171], a[204:207], v[88:91], v[156:171]
    ds_read_b64_tr_b16 v[82:83], v192 offset:58880
    buffer_load_dwordx4 v196, s[56:59], s100 offen lds
    v_rcp_f32 v182, v182
    v_rcp_f32 v183, v183
    s_waitcnt lgkmcnt(6)
    v_mfma_f32_32x32x16_bf16 v[140:155], a[208:211], v[68:71], v[140:155]
    ds_read_b64_tr_b16 v[84:85], v192 offset:59392
    s_add_u32 m0, s18, 9216
    v_mul_f32 v120, v120, v180
    v_mul_f32 v121, v121, v181
    v_mul_f32 v122, v122, v182
    v_mul_f32 v123, v123, v183
    v_mfma_f32_32x32x16_bf16 v[156:171], a[212:215], v[68:71], v[156:171]
    ds_read_b64_tr_b16 v[86:87], v192 offset:59904
    buffer_load_dwordx4 v197, s[56:59], s100 offen lds
    v_cvt_pk_bf16_f32 v190, v120, v121
    v_cvt_pk_bf16_f32 v191, v122, v123
    s_waitcnt lgkmcnt(6)
    v_mfma_f32_32x32x16_bf16 v[140:155], a[216:219], v[72:75], v[140:155]
    ds_read_b64_tr_b16 v[88:89], v192 offset:60416
    v_mfma_f32_32x32x16_bf16 v[156:171], a[220:223], v[72:75], v[156:171]
    ds_read_b64_tr_b16 v[90:91], v192 offset:60928
    s_waitcnt vmcnt(11)
    s_mov_b32 s90, 0
Ls2_29:
    v_cmp_ne_u32 vcc, s65, v15
    v_cmp_ne_u32 s[86:87], s65, v17
    s_nop 0
    s_or_b64 vcc, vcc, s[86:87]
    v_cmp_ne_u32 s[86:87], s65, v19
    s_nop 0
    s_or_b64 vcc, vcc, s[86:87]
    s_cbranch_vccz Ls2d_30
    buffer_load_dwordx2 v[14:15], v12, s[40:43], 0 offen offset:256 sc1
    buffer_load_dwordx2 v[16:17], v12, s[40:43], 0 offen offset:512 sc1
    buffer_load_dwordx2 v[18:19], v12, s[40:43], 0 offen offset:768 sc1
    s_waitcnt vmcnt(0)
    s_add_u32 s90, s90, 1
    s_cmp_lt_u32 s90, 50000
    s_cbranch_scc1 Ls2_29
Ls2d_30:
    buffer_store_dwordx4 v[188:191], v11, s[40:43], s73 offen offset:1024 sc1
    s_waitcnt lgkmcnt(6)
    v_mfma_f32_32x32x16_bf16 v[108:123], a[0:3], v[76:79], 0
    ds_read_b64_tr_b16 v[68:69], v192 offset:61440
    s_mov_b32 s73, 114688
    v_mfma_f32_32x32x16_bf16 v[124:139], a[4:7], v[76:79], 0
    ds_read_b64_tr_b16 v[70:71], v192 offset:61952
    v_lshlrev_b32 v22, 16, v14
    s_waitcnt lgkmcnt(6)
    v_mfma_f32_32x32x16_bf16 v[108:123], a[8:11], v[80:83], v[108:123]
    ds_read_b64_tr_b16 v[72:73], v192 offset:62464
    v_and_b32 v23, 0xffff0000, v14
    v_mfma_f32_32x32x16_bf16 v[124:139], a[12:15], v[80:83], v[124:139]
    ds_read_b64_tr_b16 v[74:75], v192 offset:62976
    s_barrier
    s_waitcnt lgkmcnt(6)
    v_mfma_f32_32x32x16_bf16 v[108:123], a[16:19], v[84:87], v[108:123]
    ds_read_b64_tr_b16 v[76:77], v192 offset:63488
    v_cvt_pk_bf16_f32 v28, -v22, -v22
    v_mfma_f32_32x32x16_bf16 v[124:139], a[20:23], v[84:87], v[124:139]
    ds_read_b64_tr_b16 v[78:79], v192 offset:64000
    s_add_u32 s100, s24, 71680
    v_rcp_f32 v24, v23
    s_waitcnt lgkmcnt(6)
    v_mfma_f32_32x32x16_bf16 v[108:123], a[24:27], v[88:91], v[108:123]
    ds_read_b64_tr_b16 v[80:81], v193 offset:57344
    v_mul_f32 v174, v23, v23
    v_mul_f32 v173, 0xbfb8aa3b, v24
    v_mfma_f32_32x32x16_bf16 v[124:139], a[28:31], v[88:91], v[124:139]
    ds_read_b64_tr_b16 v[82:83], v193 offset:57856
    s_add_u32 m0, s18, 10240
    v_mfma_f32_32x32x16_bf16 v[140:155], v[204:207], v[28:31], v[140:155]
    buffer_load_dwordx4 v196, s[56:59], s100 offen lds
    v_mfma_f32_32x32x16_bf16 v[156:171], v[208:211], v[28:31], v[156:171]
    s_add_u32 m0, s18, 11264
    s_waitcnt lgkmcnt(6)
    v_mfma_f32_32x32x16_bf16 v[108:123], a[32:35], v[68:71], v[108:123]
    ds_read_b64_tr_b16 v[84:85], v193 offset:58368
    v_mfma_f32_32x32x16_bf16 v[124:139], a[36:39], v[68:71], v[124:139]
    ds_read_b64_tr_b16 v[86:87], v193 offset:58880
    buffer_load_dwordx4 v197, s[56:59], s100 offen lds
    s_waitcnt lgkmcnt(6)
    v_mfma_f32_32x32x16_bf16 v[108:123], a[40:43], v[72:75], v[108:123]
    ds_read_b64_tr_b16 v[88:89], v193 offset:59392
    s_add_u32 s100, s24, 86016
    v_mul_f32 v176, v173, v140
    v_mul_f32 v177, v173, v141
    v_mul_f32 v178, v173, v142
    v_mfma_f32_32x32x16_bf16 v[124:139], a[44:47], v[72:75], v[124:139]
    ds_read_b64_tr_b16 v[90:91], v193 offset:59904
    v_mul_f32 v179, v173, v143
    v_mul_f32 v140, v140, v156
    v_mul_f32 v141, v141, v157
    s_waitcnt lgkmcnt(6)
    v_mfma_f32_32x32x16_bf16 v[108:123], a[48:51], v[76:79], v[108:123]
    ds_read_b64_tr_b16 v[68:69], v193 offset:60416
    s_add_u32 m0, s18, 12288
    v_mul_f32 v142, v142, v158
    v_mul_f32 v143, v143, v159
    v_exp_f32 v176, v176
    v_mfma_f32_32x32x16_bf16 v[124:139], a[52:55], v[76:79], v[124:139]
    ds_read_b64_tr_b16 v[70:71], v193 offset:60928
    buffer_load_dwordx4 v196, s[56:59], s100 offen lds
    v_exp_f32 v177, v177
    s_waitcnt lgkmcnt(6)
    v_mfma_f32_32x32x16_bf16 v[108:123], a[56:59], v[80:83], v[108:123]
    ds_read_b64_tr_b16 v[72:73], v193 offset:61440
    v_exp_f32 v178, v178
    v_exp_f32 v179, v179
    v_fma_f32 v176, v176, v174, v174
    v_mfma_f32_32x32x16_bf16 v[124:139], a[60:63], v[80:83], v[124:139]
    ds_read_b64_tr_b16 v[74:75], v193 offset:61952
    s_add_u32 m0, s18, 13312
    v_fma_f32 v177, v177, v174, v174
    v_fma_f32 v178, v178, v174, v174
    s_waitcnt lgkmcnt(6)
    v_mfma_f32_32x32x16_bf16 v[108:123], a[64:67], v[84:87], v[108:123]
    ds_read_b64_tr_b16 v[76:77], v193 offset:62464
    buffer_load_dwordx4 v197, s[56:59], s100 offen lds
    v_fma_f32 v179, v179, v174, v174
    v_rcp_f32 v176, v176
    v_mfma_f32_32x32x16_bf16 v[124:139], a[68:71], v[84:87], v[124:139]
    ds_read_b64_tr_b16 v[78:79], v193 offset:62976
    v_rcp_f32 v177, v177
    v_rcp_f32 v178, v178
    s_waitcnt lgkmcnt(6)
    v_mfma_f32_32x32x16_bf16 v[108:123], a[72:75], v[88:91], v[108:123]
    ds_read_b64_tr_b16 v[80:81], v193 offset:63488
    s_add_u32 s100, s25, 0
    v_rcp_f32 v179, v179
    v_mul_f32 v140, v140, v176
    v_mfma_f32_32x32x16_bf16 v[124:139], a[76:79], v[88:91], v[124:139]
    ds_read_b64_tr_b16 v[82:83], v193 offset:64000
    s_add_u32 m0, s18, 14336
    v_mul_f32 v141, v141, v177
    v_mul_f32 v142, v142, v178
    v_mul_f32 v143, v143, v179
    s_waitcnt lgkmcnt(6)
    v_mfma_f32_32x32x16_bf16 v[108:123], a[80:83], v[68:71], v[108:123]
    ds_read_b64_tr_b16 v[84:85], v194 offset:57344
    v_cvt_pk_bf16_f32 v184, v140, v141
    v_cvt_pk_bf16_f32 v185, v142, v143
    v_mul_f32 v180, v173, v144
    v_mul_f32 v181, v173, v145
    v_mfma_f32_32x32x16_bf16 v[124:139], a[84:87], v[68:71], v[124:139]
    ds_read_b64_tr_b16 v[86:87], v194 offset:57856
    buffer_load_dwordx4 v196, s[56:59], s100 offen lds
    v_mul_f32 v182, v173, v146
    v_mul_f32 v183, v173, v147
    s_waitcnt lgkmcnt(6)
    v_mfma_f32_32x32x16_bf16 v[108:123], a[88:91], v[72:75], v[108:123]
    ds_read_b64_tr_b16 v[88:89], v194 offset:58368
    s_add_u32 m0, s18, 15360
    v_mul_f32 v144, v144, v160
    v_mul_f32 v145, v145, v161
    v_mul_f32 v146, v146, v162
    v_mul_f32 v147, v147, v163
    v_mfma_f32_32x32x16_bf16 v[124:139], a[92:95], v[72:75], v[124:139]
    ds_read_b64_tr_b16 v[90:91], v194 offset:58880
    v_exp_f32 v180, v180
    s_waitcnt lgkmcnt(6)
    v_mfma_f32_32x32x16_bf16 v[108:123], a[96:99], v[76:79], v[108:123]
    ds_read_b64_tr_b16 v[68:69], v194 offset:59392
    buffer_load_dwordx4 v197, s[56:59], s100 offen lds
    v_exp_f32 v181, v181
    v_exp_f32 v182, v182
    v_mfma_f32_32x32x16_bf16 v[124:139], a[100:103], v[76:79], v[124:139]
    ds_read_b64_tr_b16 v[70:71], v194 offset:59904
    s_add_u32 s100, s25, 14336
    v_exp_f32 v183, v183
    v_fma_f32 v180, v180, v174, v174
    s_waitcnt lgkmcnt(6)
    v_mfma_f32_32x32x16_bf16 v[108:123], a[104:107], v[80:83], v[108:123]
    ds_read_b64_tr_b16 v[72:73], v194 offset:60416
    s_add_u32 m0, s18, 16384
    v_fma_f32 v181, v181, v174, v174
    v_fma_f32 v182, v182, v174, v174
    v_fma_f32 v183, v183, v174, v174
    v_mfma_f32_32x32x16_bf16 v[124:139], a[108:111], v[80:83], v[124:139]
    ds_read_b64_tr_b16 v[74:75], v194 offset:60928
    v_rcp_f32 v180, v180
    v_rcp_f32 v181, v181
    s_waitcnt lgkmcnt(6)
    v_mfma_f32_32x32x16_bf16 v[108:123], a[112:115], v[84:87], v[108:123]
    ds_read_b64_tr_b16 v[76:77], v194 offset:61440
    buffer_load_dwordx4 v196, s[56:59], s100 offen lds
    v_rcp_f32 v182, v182
    v_mfma_f32_32x32x16_bf16 v[124:139], a[116:119], v[84:87], v[124:139]
    ds_read_b64_tr_b16 v[78:79], v194 offset:61952
    s_add_u32 m0, s18, 17408
    v_rcp_f32 v183, v183
    v_mul_f32 v144, v144, v180
    v_mul_f32 v145, v145, v181
    s_waitcnt lgkmcnt(6)
    v_mfma_f32_32x32x16_bf16 v[108:123], a[120:123], v[88:91], v[108:123]
    ds_read_b64_tr_b16 v[80:81], v194 offset:62464
    v_mul_f32 v146, v146, v182
    v_mul_f32 v147, v147, v183
    v_cvt_pk_bf16_f32 v186, v144, v145
    v_cvt_pk_bf16_f32 v187, v146, v147
    v_mfma_f32_32x32x16_bf16 v[124:139], a[124:127], v[88:91], v[124:139]
    ds_read_b64_tr_b16 v[82:83], v194 offset:62976
    buffer_load_dwordx4 v197, s[56:59], s100 offen lds
    v_mul_f32 v176, v173, v148
    v_mul_f32 v177, v173, v149
    v_mul_f32 v178, v173, v150
    s_waitcnt lgkmcnt(6)
    v_mfma_f32_32x32x16_bf16 v[108:123], a[128:131], v[68:71], v[108:123]
    ds_read_b64_tr_b16 v[84:85], v194 offset:63488
    s_add_u32 s100, s25, 28672
    v_mul_f32 v179, v173, v151
    v_mul_f32 v148, v148, v164
    v_mul_f32 v149, v149, v165
    v_mfma_f32_32x32x16_bf16 v[124:139], a[132:135], v[68:71], v[124:139]
    ds_read_b64_tr_b16 v[86:87], v194 offset:64000
    v_mul_f32 v150, v150, v166
    s_waitcnt lgkmcnt(6)
    v_mfma_f32_32x32x16_bf16 v[108:123], a[136:139], v[72:75], v[108:123]
    ds_read_b64_tr_b16 v[88:89], v195 offset:57344
    s_add_u32 m0, s19, 0
    buffer_store_dwordx4 v[184:187], v11, s[40:43], s73 offen offset:0 sc1
    v_mfma_f32_32x32x16_bf16 v[124:139], a[140:143], v[72:75], v[124:139]
    ds_read_b64_tr_b16 v[90:91], v195 offset:57856
    buffer_load_dwordx4 v196, s[56:59], s100 offen lds
    v_mul_f32 v151, v151, v167
    s_waitcnt lgkmcnt(6)
    v_mfma_f32_32x32x16_bf16 v[108:123], a[144:147], v[76:79], v[108:123]
    ds_read_b64_tr_b16 v[68:69], v195 offset:58368
    v_exp_f32 v176, v176
    v_exp_f32 v177, v177
    v_exp_f32 v178, v178
    v_mfma_f32_32x32x16_bf16 v[124:139], a[148:151], v[76:79], v[124:139]
    ds_read_b64_tr_b16 v[70:71], v195 offset:58880
    s_add_u32 m0, s19, 1024
    v_exp_f32 v179, v179
    s_waitcnt lgkmcnt(6)
    v_mfma_f32_32x32x16_bf16 v[108:123], a[152:155], v[80:83], v[108:123]
    ds_read_b64_tr_b16 v[72:73], v195 offset:59392
    buffer_load_dwordx4 v197, s[56:59], s100 offen lds
    v_fma_f32 v176, v176, v174, v174
    v_fma_f32 v177, v177, v174, v174
    v_fma_f32 v178, v178, v174, v174
    v_mfma_f32_32x32x16_bf16 v[124:139], a[156:159], v[80:83], v[124:139]
    ds_read_b64_tr_b16 v[74:75], v195 offset:59904
    v_fma_f32 v179, v179, v174, v174
    v_rcp_f32 v176, v176
    s_waitcnt lgkmcnt(6)
    v_mfma_f32_32x32x16_bf16 v[108:123], a[160:163], v[84:87], v[108:123]
    ds_read_b64_tr_b16 v[76:77], v195 offset:60416
    s_add_u32 s100, s25, 43008
    v_rcp_f32 v177, v177
    v_rcp_f32 v178, v178
    v_mfma_f32_32x32x16_bf16 v[124:139], a[164:167], v[84:87], v[124:139]
    ds_read_b64_tr_b16 v[78:79], v195 offset:60928
    s_add_u32 m0, s19, 2048
    v_rcp_f32 v179, v179
    v_mul_f32 v148, v148, v176
    s_waitcnt lgkmcnt(6)
    v_mfma_f32_32x32x16_bf16 v[108:123], a[168:171], v[88:91], v[108:123]
    ds_read_b64_tr_b16 v[80:81], v195 offset:61440
    v_mul_f32 v149, v149, v177
    v_mul_f32 v150, v150, v178
    v_mul_f32 v151, v151, v179
    v_cvt_pk_bf16_f32 v188, v148, v149
    v_mfma_f32_32x32x16_bf16 v[124:139], a[172:175], v[88:91], v[124:139]
    ds_read_b64_tr_b16 v[82:83], v195 offset:61952
    buffer_load_dwordx4 v196, s[56:59], s100 offen lds
    v_cvt_pk_bf16_f32 v189, v150, v151
    s_barrier
    s_waitcnt lgkmcnt(6)
    v_mfma_f32_32x32x16_bf16 v[108:123], a[176:179], v[68:71], v[108:123]
    ds_read_b64_tr_b16 v[84:85], v195 offset:62464
    v_mul_f32 v180, v173, v152
    v_mul_f32 v181, v173, v153
    v_mul_f32 v182, v173, v154
    v_mul_f32 v183, v173, v155
    v_mfma_f32_32x32x16_bf16 v[124:139], a[180:183], v[68:71], v[124:139]
    ds_read_b64_tr_b16 v[86:87], v195 offset:62976
    s_add_u32 m0, s19, 3072
    v_mul_f32 v152, v152, v168
    v_mul_f32 v153, v153, v169
    s_waitcnt lgkmcnt(6)
    v_mfma_f32_32x32x16_bf16 v[108:123], a[184:187], v[72:75], v[108:123]
    ds_read_b64_tr_b16 v[88:89], v195 offset:63488
    buffer_load_dwordx4 v197, s[56:59], s100 offen lds
    v_mul_f32 v154, v154, v170
    v_mul_f32 v155, v155, v171
    v_exp_f32 v180, v180
    v_mfma_f32_32x32x16_bf16 v[124:139], a[188:191], v[72:75], v[124:139]
    ds_read_b64_tr_b16 v[90:91], v195 offset:64000
    v_exp_f32 v181, v181
    s_waitcnt lgkmcnt(6)
    v_mfma_f32_32x32x16_bf16 v[108:123], a[192:195], v[76:79], v[108:123]
    ds_read_b64_tr_b16 v[68:69], v192 offset:0
    s_add_u32 s100, s25, 57344
    v_exp_f32 v182, v182
    v_exp_f32 v183, v183
    v_fma_f32 v180, v180, v174, v174
    v_mfma_f32_32x32x16_bf16 v[124:139], a[196:199], v[76:79], v[124:139]
    ds_read_b64_tr_b16 v[70:71], v192 offset:512
    s_add_u32 m0, s19, 4096
    v_fma_f32 v181, v181, v174, v174
    v_fma_f32 v182, v182, v174, v174
    s_waitcnt lgkmcnt(6)
    v_mfma_f32_32x32x16_bf16 v[108:123], a[200:203], v[80:83], v[108:123]
    ds_read_b64_tr_b16 v[72:73], v192 offset:1024
    buffer_load_dwordx4 v196, s[56:59], s100 offen lds
    v_fma_f32 v183, v183, v174, v174
    v_rcp_f32 v180, v180
    v_mfma_f32_32x32x16_bf16 v[124:139], a[204:207], v[80:83], v[124:139]
    ds_read_b64_tr_b16 v[74:75], v192 offset:1536
    v_rcp_f32 v181, v181
    v_rcp_f32 v182, v182
    s_waitcnt lgkmcnt(6)
    v_mfma_f32_32x32x16_bf16 v[108:123], a[208:211], v[84:87], v[108:123]
    ds_read_b64_tr_b16 v[76:77], v192 offset:2048
    s_add_u32 m0, s19, 5120
    v_rcp_f32 v183, v183
    v_mul_f32 v152, v152, v180
    v_mfma_f32_32x32x16_bf16 v[124:139], a[212:215], v[84:87], v[124:139]
    ds_read_b64_tr_b16 v[78:79], v192 offset:2560
    buffer_load_dwordx4 v197, s[56:59], s100 offen lds
    v_mul_f32 v153, v153, v181
    v_mul_f32 v154, v154, v182
    v_mul_f32 v155, v155, v183
    s_waitcnt lgkmcnt(6)
    v_mfma_f32_32x32x16_bf16 v[108:123], a[216:219], v[88:91], v[108:123]
    ds_read_b64_tr_b16 v[80:81], v192 offset:3072
    v_cvt_pk_bf16_f32 v190, v152, v153
    v_cvt_pk_bf16_f32 v191, v154, v155
    v_mfma_f32_32x32x16_bf16 v[124:139], a[220:223], v[88:91], v[124:139]
    ds_read_b64_tr_b16 v[82:83], v192 offset:3584
    buffer_store_dwordx4 v[188:191], v11, s[40:43], s73 offen offset:1024 sc1
    s_waitcnt lgkmcnt(6)
    v_mfma_f32_32x32x16_bf16 v[140:155], a[0:3], v[68:71], 0
    ds_read_b64_tr_b16 v[84:85], v192 offset:4096
    s_mov_b32 s73, 229376
    v_mfma_f32_32x32x16_bf16 v[156:171], a[4:7], v[68:71], 0
    ds_read_b64_tr_b16 v[86:87], v192 offset:4608
    v_lshlrev_b32 v22, 16, v16
    s_waitcnt lgkmcnt(6)
    v_mfma_f32_32x32x16_bf16 v[140:155], a[8:11], v[72:75], v[140:155]
    ds_read_b64_tr_b16 v[88:89], v192 offset:5120
    v_and_b32 v23, 0xffff0000, v16
    v_mfma_f32_32x32x16_bf16 v[156:171], a[12:15], v[72:75], v[156:171]
    ds_read_b64_tr_b16 v[90:91], v192 offset:5632
    s_barrier
    s_waitcnt lgkmcnt(6)
    v_mfma_f32_32x32x16_bf16 v[140:155], a[16:19], v[76:79], v[140:155]
    ds_read_b64_tr_b16 v[68:69], v192 offset:6144
    v_cvt_pk_bf16_f32 v28, -v22, -v22
    v_mfma_f32_32x32x16_bf16 v[156:171], a[20:23], v[76:79], v[156:171]
    ds_read_b64_tr_b16 v[70:71], v192 offset:6656
    s_add_u32 s100, s25, 71680
    v_rcp_f32 v24, v23
    s_waitcnt lgkmcnt(6)
    v_mfma_f32_32x32x16_bf16 v[140:155], a[24:27], v[80:83], v[140:155]
    ds_read_b64_tr_b16 v[72:73], v193 offset:0
    v_mul_f32 v174, v23, v23
    v_mul_f32 v173, 0xbfb8aa3b, v24
    v_mfma_f32_32x32x16_bf16 v[156:171], a[28:31], v[80:83], v[156:171]
    ds_read_b64_tr_b16 v[74:75], v193 offset:512
    s_add_u32 m0, s20, 0
    v_mfma_f32_32x32x16_bf16 v[108:123], v[204:207], v[28:31], v[108:123]
    buffer_load_dwordx4 v196, s[56:59], s100 offen lds
    v_mfma_f32_32x32x16_bf16 v[124:139], v[208:211], v[28:31], v[124:139]
    s_add_u32 m0, s20, 1024
    s_nop 0
    buffer_load_dwordx4 v197, s[56:59], s100 offen lds
    s_waitcnt lgkmcnt(6)
    v_mfma_f32_32x32x16_bf16 v[140:155], a[32:35], v[84:87], v[140:155]
    ds_read_b64_tr_b16 v[76:77], v193 offset:1024
    v_mfma_f32_32x32x16_bf16 v[156:171], a[36:39], v[84:87], v[156:171]
    ds_read_b64_tr_b16 v[78:79], v193 offset:1536
    s_add_u32 s100, s25, 86016
    s_waitcnt lgkmcnt(6)
    v_mfma_f32_32x32x16_bf16 v[140:155], a[40:43], v[88:91], v[140:155]
    ds_read_b64_tr_b16 v[80:81], v193 offset:2048
    s_add_u32 m0, s20, 2048
    v_mul_f32 v176, v173, v108
    v_mul_f32 v177, v173, v109
    v_mul_f32 v178, v173, v110
    v_mul_f32 v179, v173, v111
    v_mfma_f32_32x32x16_bf16 v[156:171], a[44:47], v[88:91], v[156:171]
    ds_read_b64_tr_b16 v[82:83], v193 offset:2560
    buffer_load_dwordx4 v196, s[56:59], s100 offen lds
    v_mul_f32 v108, v108, v124
    v_mul_f32 v109, v109, v125
    v_mul_f32 v110, v110, v126
    s_waitcnt lgkmcnt(6)
    v_mfma_f32_32x32x16_bf16 v[140:155], a[48:51], v[68:71], v[140:155]
    ds_read_b64_tr_b16 v[84:85], v193 offset:3072
    s_add_u32 m0, s20, 3072
    v_mul_f32 v111, v111, v127
    v_exp_f32 v176, v176
    v_mfma_f32_32x32x16_bf16 v[156:171], a[52:55], v[68:71], v[156:171]
    ds_read_b64_tr_b16 v[86:87], v193 offset:3584
    buffer_load_dwordx4 v197, s[56:59], s100 offen lds
    v_exp_f32 v177, v177
    v_exp_f32 v178, v178
    s_waitcnt lgkmcnt(6)
    v_mfma_f32_32x32x16_bf16 v[140:155], a[56:59], v[72:75], v[140:155]
    ds_read_b64_tr_b16 v[88:89], v193 offset:4096
    v_exp_f32 v179, v179
    v_fma_f32 v176, v176, v174, v174
    v_fma_f32 v177, v177, v174, v174
    v_fma_f32 v178, v178, v174, v174
    v_mfma_f32_32x32x16_bf16 v[156:171], a[60:63], v[72:75], v[156:171]
    ds_read_b64_tr_b16 v[90:91], v193 offset:4608
    s_add_u32 s100, s26, 0
    v_fma_f32 v179, v179, v174, v174
    v_rcp_f32 v176, v176
    s_waitcnt lgkmcnt(6)
    v_mfma_f32_32x32x16_bf16 v[140:155], a[64:67], v[76:79], v[140:155]
    ds_read_b64_tr_b16 v[68:69], v193 offset:5120
    s_add_u32 m0, s20, 4096
    v_rcp_f32 v177, v177
    v_rcp_f32 v178, v178
    v_mfma_f32_32x32x16_bf16 v[156:171], a[68:71], v[76:79], v[156:171]
    ds_read_b64_tr_b16 v[70:71], v193 offset:5632
    buffer_load_dwordx4 v196, s[56:59], s100 offen lds
    v_rcp_f32 v179, v179
    v_mul_f32 v108, v108, v176
    s_waitcnt lgkmcnt(6)
    v_mfma_f32_32x32x16_bf16 v[140:155], a[72:75], v[80:83], v[140:155]
    ds_read_b64_tr_b16 v[72:73], v193 offset:6144
    s_add_u32 m0, s20, 5120
    v_mul_f32 v109, v109, v177
    v_mul_f32 v110, v110, v178
    v_mul_f32 v111, v111, v179
    v_cvt_pk_bf16_f32 v184, v108, v109
    v_mfma_f32_32x32x16_bf16 v[156:171], a[76:79], v[80:83], v[156:171]
    ds_read_b64_tr_b16 v[74:75], v193 offset:6656
    buffer_load_dwordx4 v197, s[56:59], s100 offen lds
    v_cvt_pk_bf16_f32 v185, v110, v111
    v_mul_f32 v180, v173, v112
    v_mul_f32 v181, v173, v113
    s_waitcnt lgkmcnt(6)
    v_mfma_f32_32x32x16_bf16 v[140:155], a[80:83], v[84:87], v[140:155]
    ds_read_b64_tr_b16 v[76:77], v194 offset:0
    s_waitcnt vmcnt(14)
    ds_read_b64_tr_b16 a[0:1], v198 offset:0
    v_mul_f32 v182, v173, v114
    v_mul_f32 v183, v173, v115
    v_mul_f32 v112, v112, v128
    v_mfma_f32_32x32x16_bf16 v[156:171], a[84:87], v[84:87], v[156:171]
    ds_read_b64_tr_b16 v[78:79], v194 offset:512
    ds_read_b64_tr_b16 a[2:3], v198 offset:1024
    v_mul_f32 v113, v113, v129
    v_mul_f32 v114, v114, v130
    s_waitcnt lgkmcnt(8)
    v_mfma_f32_32x32x16_bf16 v[140:155], a[88:91], v[88:91], v[140:155]
    ds_read_b64_tr_b16 v[80:81], v194 offset:1024
    ds_read_b64_tr_b16 a[4:5], v199 offset:0
    v_mul_f32 v115, v115, v131
    v_exp_f32 v180, v180
    v_mfma_f32_32x32x16_bf16 v[156:171], a[92:95], v[88:91], v[156:171]
    ds_read_b64_tr_b16 v[82:83], v194 offset:1536
    ds_read_b64_tr_b16 a[6:7], v199 offset:1024
    v_exp_f32 v181, v181
    s_waitcnt lgkmcnt(10)
    v_mfma_f32_32x32x16_bf16 v[140:155], a[96:99], v[68:71], v[140:155]
    ds_read_b64_tr_b16 v[84:85], v194 offset:2048
    ds_read_b64_tr_b16 a[8:9], v198 offset:2048
    v_exp_f32 v182, v182
    v_exp_f32 v183, v183
    v_fma_f32 v180, v180, v174, v174
    v_mfma_f32_32x32x16_bf16 v[156:171], a[100:103], v[68:71], v[156:171]
    ds_read_b64_tr_b16 v[86:87], v194 offset:2560
    ds_read_b64_tr_b16 a[10:11], v198 offset:3072
    v_fma_f32 v181, v181, v174, v174
    v_fma_f32 v182, v182, v174, v174
    v_fma_f32 v183, v183, v174, v174
    s_waitcnt lgkmcnt(12)
    v_mfma_f32_32x32x16_bf16 v[140:155], a[104:107], v[72:75], v[140:155]
    ds_read_b64_tr_b16 v[88:89], v194 offset:3072
    ds_read_b64_tr_b16 a[12:13], v199 offset:2048
    v_rcp_f32 v180, v180
    v_mfma_f32_32x32x16_bf16 v[156:171], a[108:111], v[72:75], v[156:171]
    ds_read_b64_tr_b16 v[90:91], v194 offset:3584
    ds_read_b64_tr_b16 a[14:15], v199 offset:3072
    v_rcp_f32 v181, v181
    v_rcp_f32 v182, v182
    s_waitcnt lgkmcnt(13)
    v_mfma_f32_32x32x16_bf16 v[140:155], a[112:115], v[76:79], v[140:155]
    ds_read_b64_tr_b16 v[68:69], v194 offset:4096
    ds_read_b64_tr_b16 a[16:17], v198 offset:4096
    v_rcp_f32 v183, v183
    v_mul_f32 v112, v112, v180
    v_mfma_f32_32x32x16_bf16 v[156:171], a[116:119], v[76:79], v[156:171]
    ds_read_b64_tr_b16 v[70:71], v194 offset:4608
    ds_read_b64_tr_b16 a[18:19], v198 offset:5120
    v_mul_f32 v113, v113, v181
    v_mul_f32 v114, v114, v182
    v_mul_f32 v115, v115, v183
    s_waitcnt lgkmcnt(13)
    v_mfma_f32_32x32x16_bf16 v[140:155], a[120:123], v[80:83], v[140:155]
    ds_read_b64_tr_b16 v[72:73], v194 offset:5120
    ds_read_b64_tr_b16 a[20:21], v199 offset:4096
    v_cvt_pk_bf16_f32 v186, v112, v113
    v_cvt_pk_bf16_f32 v187, v114, v115
    v_mul_f32 v176, v173, v116
    v_mfma_f32_32x32x16_bf16 v[156:171], a[124:127], v[80:83], v[156:171]
    ds_read_b64_tr_b16 v[74:75], v194 offset:5632
    ds_read_b64_tr_b16 a[22:23], v199 offset:5120
    v_mul_f32 v177, v173, v117
    v_mul_f32 v178, v173, v118
    v_mul_f32 v179, v173, v119
    s_waitcnt lgkmcnt(13)
    v_mfma_f32_32x32x16_bf16 v[140:155], a[128:131], v[84:87], v[140:155]
    ds_read_b64_tr_b16 v[76:77], v194 offset:6144
    ds_read_b64_tr_b16 a[24:25], v198 offset:6144
    v_mul_f32 v116, v116, v132
    v_mul_f32 v117, v117, v133
    v_mul_f32 v118, v118, v134
    v_mfma_f32_32x32x16_bf16 v[156:171], a[132:135], v[84:87], v[156:171]
    ds_read_b64_tr_b16 v[78:79], v194 offset:6656
    ds_read_b64_tr_b16 a[26:27], v198 offset:7168
    s_waitcnt lgkmcnt(13)
    v_mfma_f32_32x32x16_bf16 v[140:155], a[136:139], v[88:91], v[140:155]
    ds_read_b64_tr_b16 v[80:81], v195 offset:0
    ds_read_b64_tr_b16 a[28:29], v199 offset:6144
    buffer_store_dwordx4 v[184:187], v11, s[40:43], s73 offen offset:0 sc1
    v_mul_f32 v119, v119, v135
    v_mfma_f32_32x32x16_bf16 v[156:171], a[140:143], v[88:91], v[156:171]
    ds_read_b64_tr_b16 v[82:83], v195 offset:512
    ds_read_b64_tr_b16 a[30:31], v199 offset:7168
    v_exp_f32 v176, v176
    s_waitcnt lgkmcnt(13)
    v_mfma_f32_32x32x16_bf16 v[140:155], a[144:147], v[68:71], v[140:155]
    ds_read_b64_tr_b16 v[84:85], v195 offset:1024
    ds_read_b64_tr_b16 a[32:33], v198 offset:8192
    v_exp_f32 v177, v177
    v_exp_f32 v178, v178
    v_mfma_f32_32x32x16_bf16 v[156:171], a[148:151], v[68:71], v[156:171]
    ds_read_b64_tr_b16 v[86:87], v195 offset:1536
    ds_read_b64_tr_b16 a[34:35], v198 offset:9216
    v_exp_f32 v179, v179
    s_waitcnt lgkmcnt(13)
    v_mfma_f32_32x32x16_bf16 v[140:155], a[152:155], v[72:75], v[140:155]
    ds_read_b64_tr_b16 v[88:89], v195 offset:2048
    ds_read_b64_tr_b16 a[36:37], v199 offset:8192
    v_fma_f32 v176, v176, v174, v174
    v_fma_f32 v177, v177, v174, v174
    v_fma_f32 v178, v178, v174, v174
    v_fma_f32 v179, v179, v174, v174
    v_mfma_f32_32x32x16_bf16 v[156:171], a[156:159], v[72:75], v[156:171]
    ds_read_b64_tr_b16 v[90:91], v195 offset:2560
    ds_read_b64_tr_b16 a[38:39], v199 offset:9216
    v_rcp_f32 v176, v176
    s_waitcnt lgkmcnt(13)
    v_mfma_f32_32x32x16_bf16 v[140:155], a[160:163], v[76:79], v[140:155]
    ds_read_b64_tr_b16 v[68:69], v195 offset:3072
    ds_read_b64_tr_b16 a[40:41], v198 offset:10240
    v_rcp_f32 v177, v177
    v_rcp_f32 v178, v178
    v_mfma_f32_32x32x16_bf16 v[156:171], a[164:167], v[76:79], v[156:171]
    ds_read_b64_tr_b16 v[70:71], v195 offset:3584
    ds_read_b64_tr_b16 a[42:43], v198 offset:11264
    v_rcp_f32 v179, v179
    v_mul_f32 v116, v116, v176
    s_waitcnt lgkmcnt(13)
    v_mfma_f32_32x32x16_bf16 v[140:155], a[168:171], v[80:83], v[140:155]
    ds_read_b64_tr_b16 v[72:73], v195 offset:4096
    ds_read_b64_tr_b16 a[44:45], v199 offset:10240
    v_mul_f32 v117, v117, v177
    v_mul_f32 v118, v118, v178
    v_mul_f32 v119, v119, v179
    v_mfma_f32_32x32x16_bf16 v[156:171], a[172:175], v[80:83], v[156:171]
    ds_read_b64_tr_b16 v[74:75], v195 offset:4608
    ds_read_b64_tr_b16 a[46:47], v199 offset:11264
    v_cvt_pk_bf16_f32 v188, v116, v117
    v_cvt_pk_bf16_f32 v189, v118, v119
    s_barrier
    s_waitcnt lgkmcnt(13)
    v_mfma_f32_32x32x16_bf16 v[140:155], a[176:179], v[84:87], v[140:155]
    ds_read_b64_tr_b16 v[76:77], v195 offset:5120
    ds_read_b64_tr_b16 a[48:49], v198 offset:12288
    v_mul_f32 v180, v173, v120
    v_mul_f32 v181, v173, v121
    v_mul_f32 v182, v173, v122
    v_mfma_f32_32x32x16_bf16 v[156:171], a[180:183], v[84:87], v[156:171]
    ds_read_b64_tr_b16 v[78:79], v195 offset:5632
    ds_read_b64_tr_b16 a[50:51], v198 offset:13312
    v_mul_f32 v183, v173, v123
    v_mul_f32 v120, v120, v136
    v_mul_f32 v121, v121, v137
    s_waitcnt lgkmcnt(13)
    v_mfma_f32_32x32x16_bf16 v[140:155], a[184:187], v[88:91], v[140:155]
    ds_read_b64_tr_b16 v[80:81], v195 offset:6144
    ds_read_b64_tr_b16 a[52:53], v199 offset:12288
    v_mul_f32 v122, v122, v138
    v_mul_f32 v123, v123, v139
    v_exp_f32 v180, v180
    v_mfma_f32_32x32x16_bf16 v[156:171], a[188:191], v[88:91], v[156:171]
    ds_read_b64_tr_b16 v[82:83], v195 offset:6656
    ds_read_b64_tr_b16 a[54:55], v199 offset:13312
    v_exp_f32 v181, v181
    s_waitcnt lgkmcnt(13)
    v_mfma_f32_32x32x16_bf16 v[140:155], a[192:195], v[68:71], v[140:155]
    ds_read_b64_tr_b16 a[56:57], v198 offset:14336
    v_exp_f32 v182, v182
    v_exp_f32 v183, v183
    v_fma_f32 v180, v180, v174, v174
    v_mfma_f32_32x32x16_bf16 v[156:171], a[196:199], v[68:71], v[156:171]
    ds_read_b64_tr_b16 a[58:59], v198 offset:15360
    v_fma_f32 v181, v181, v174, v174
    v_fma_f32 v182, v182, v174, v174
    v_fma_f32 v183, v183, v174, v174
    s_waitcnt lgkmcnt(11)
    v_mfma_f32_32x32x16_bf16 v[140:155], a[200:203], v[72:75], v[140:155]
    ds_read_b64_tr_b16 a[60:61], v199 offset:14336
    v_rcp_f32 v180, v180
    v_rcp_f32 v181, v181
    v_rcp_f32 v182, v182
    v_mfma_f32_32x32x16_bf16 v[156:171], a[204:207], v[72:75], v[156:171]
    ds_read_b64_tr_b16 a[62:63], v199 offset:15360
    v_rcp_f32 v183, v183
    v_mul_f32 v120, v120, v180
    v_mul_f32 v121, v121, v181
    s_waitcnt lgkmcnt(9)
    v_mfma_f32_32x32x16_bf16 v[140:155], a[208:211], v[76:79], v[140:155]
    ds_read_b64_tr_b16 a[64:65], v198 offset:16384
    v_mul_f32 v122, v122, v182
    v_mul_f32 v123, v123, v183
    v_cvt_pk_bf16_f32 v190, v120, v121
    v_cvt_pk_bf16_f32 v191, v122, v123
    v_mfma_f32_32x32x16_bf16 v[156:171], a[212:215], v[76:79], v[156:171]
    ds_read_b64_tr_b16 a[66:67], v198 offset:17408
    buffer_store_dwordx4 v[188:191], v11, s[40:43], s73 offen offset:1024 sc1
    s_waitcnt lgkmcnt(7)
    v_mfma_f32_32x32x16_bf16 v[140:155], a[216:219], v[80:83], v[140:155]
    ds_read_b64_tr_b16 a[68:69], v199 offset:16384
    v_mfma_f32_32x32x16_bf16 v[156:171], a[220:223], v[80:83], v[156:171]
    ds_read_b64_tr_b16 a[70:71], v199 offset:17408
    s_mov_b32 s73, 344064
    v_lshlrev_b32 v22, 16, v18
    v_and_b32 v23, 0xffff0000, v18
    v_cvt_pk_bf16_f32 v28, -v22, -v22
    v_rcp_f32 v24, v23
    v_mul_f32 v174, v23, v23
    v_mul_f32 v173, 0xbfb8aa3b, v24
    v_mfma_f32_32x32x16_bf16 v[140:155], v[204:207], v[28:31], v[140:155]
    v_mfma_f32_32x32x16_bf16 v[156:171], v[208:211], v[28:31], v[156:171]
    s_nop 10
    v_mul_f32 v176, v173, v140
    v_mul_f32 v177, v173, v141
    v_mul_f32 v178, v173, v142
    v_mul_f32 v179, v173, v143
    v_mul_f32 v140, v140, v156
    v_mul_f32 v141, v141, v157
    v_mul_f32 v142, v142, v158
    v_mul_f32 v143, v143, v159
    v_exp_f32 v176, v176
    v_exp_f32 v177, v177
    v_exp_f32 v178, v178
    v_exp_f32 v179, v179
    v_fma_f32 v176, v176, v174, v174
    v_fma_f32 v177, v177, v174, v174
    v_fma_f32 v178, v178, v174, v174
    v_fma_f32 v179, v179, v174, v174
    v_rcp_f32 v176, v176
    v_rcp_f32 v177, v177
    v_rcp_f32 v178, v178
    v_rcp_f32 v179, v179
    v_mul_f32 v140, v140, v176
    v_mul_f32 v141, v141, v177
    v_mul_f32 v142, v142, v178
    v_mul_f32 v143, v143, v179
    v_cvt_pk_bf16_f32 v184, v140, v141
    v_cvt_pk_bf16_f32 v185, v142, v143
    v_mul_f32 v180, v173, v144
    v_mul_f32 v181, v173, v145
    v_mul_f32 v182, v173, v146
    v_mul_f32 v183, v173, v147
    v_mul_f32 v144, v144, v160
    v_mul_f32 v145, v145, v161
    v_mul_f32 v146, v146, v162
    v_mul_f32 v147, v147, v163
    v_exp_f32 v180, v180
    v_exp_f32 v181, v181
    v_exp_f32 v182, v182
    v_exp_f32 v183, v183
    v_fma_f32 v180, v180, v174, v174
    v_fma_f32 v181, v181, v174, v174
    v_fma_f32 v182, v182, v174, v174
    v_fma_f32 v183, v183, v174, v174
    v_rcp_f32 v180, v180
    v_rcp_f32 v181, v181
    v_rcp_f32 v182, v182
    v_rcp_f32 v183, v183
    v_mul_f32 v144, v144, v180
    v_mul_f32 v145, v145, v181
    v_mul_f32 v146, v146, v182
    v_mul_f32 v147, v147, v183
    v_cvt_pk_bf16_f32 v186, v144, v145
    v_cvt_pk_bf16_f32 v187, v146, v147
    buffer_store_dwordx4 v[184:187], v11, s[40:43], s73 offen offset:0 sc1
    v_mul_f32 v176, v173, v148
    v_mul_f32 v177, v173, v149
    v_mul_f32 v178, v173, v150
    v_mul_f32 v179, v173, v151
    v_mul_f32 v148, v148, v164
    v_mul_f32 v149, v149, v165
    v_mul_f32 v150, v150, v166
    v_mul_f32 v151, v151, v167
    v_exp_f32 v176, v176
    v_exp_f32 v177, v177
    v_exp_f32 v178, v178
    v_exp_f32 v179, v179
    v_fma_f32 v176, v176, v174, v174
    v_fma_f32 v177, v177, v174, v174
    v_fma_f32 v178, v178, v174, v174
    v_fma_f32 v179, v179, v174, v174
    v_rcp_f32 v176, v176
    v_rcp_f32 v177, v177
    v_rcp_f32 v178, v178
    v_rcp_f32 v179, v179
    v_mul_f32 v148, v148, v176
    v_mul_f32 v149, v149, v177
    v_mul_f32 v150, v150, v178
    v_mul_f32 v151, v151, v179
    v_cvt_pk_bf16_f32 v188, v148, v149
    v_cvt_pk_bf16_f32 v189, v150, v151
    v_mul_f32 v180, v173, v152
    v_mul_f32 v181, v173, v153
    v_mul_f32 v182, v173, v154
    v_mul_f32 v183, v173, v155
    v_mul_f32 v152, v152, v168
    v_mul_f32 v153, v153, v169
    v_mul_f32 v154, v154, v170
    v_mul_f32 v155, v155, v171
    v_exp_f32 v180, v180
    v_exp_f32 v181, v181
    v_exp_f32 v182, v182
    v_exp_f32 v183, v183
    v_fma_f32 v180, v180, v174, v174
    v_fma_f32 v181, v181, v174, v174
    v_fma_f32 v182, v182, v174, v174
    v_fma_f32 v183, v183, v174, v174
    v_rcp_f32 v180, v180
    v_rcp_f32 v181, v181
    v_rcp_f32 v182, v182
    v_rcp_f32 v183, v183
    v_mul_f32 v152, v152, v180
    v_mul_f32 v153, v153, v181
    v_mul_f32 v154, v154, v182
    v_mul_f32 v155, v155, v183
    v_cvt_pk_bf16_f32 v190, v152, v153
    v_cvt_pk_bf16_f32 v191, v154, v155
    buffer_store_dwordx4 v[188:191], v11, s[40:43], s73 offen offset:1024 sc1
    s_add_u32 s100, s26, 14336
    s_add_u32 m0, s18, 0
    s_nop 0
    buffer_load_dwordx4 v196, s[56:59], s100 offen lds
    s_add_u32 m0, s18, 1024
    s_nop 0
    buffer_load_dwordx4 v197, s[56:59], s100 offen lds
    s_add_u32 s100, s26, 28672
    s_add_u32 m0, s18, 2048
    s_nop 0
    buffer_load_dwordx4 v196, s[56:59], s100 offen lds
    s_add_u32 m0, s18, 3072
    s_nop 0
    buffer_load_dwordx4 v197, s[56:59], s100 offen lds
    s_add_u32 s100, s26, 43008
    s_add_u32 m0, s18, 4096
    s_nop 0
    buffer_load_dwordx4 v196, s[56:59], s100 offen lds
    s_add_u32 m0, s18, 5120
    s_nop 0
    buffer_load_dwordx4 v197, s[56:59], s100 offen lds
    s_add_u32 s100, s26, 57344
    s_add_u32 m0, s18, 6144
    s_nop 0
    buffer_load_dwordx4 v196, s[56:59], s100 offen lds
    s_add_u32 m0, s18, 7168
    s_nop 0
    buffer_load_dwordx4 v197, s[56:59], s100 offen lds
    s_waitcnt vmcnt(8)
    s_barrier
    s_lshl_b32 s70, s77, 4
    s_add_u32 s70, s70, s78
    s_cmp_lg_u32 s64, 0
    s_cbranch_scc1 Lsig_31
    s_mul_i32 s69, s70, 16
    s_add_u32 s69, s69, 49152
    v_mov_b32 v2, s65
    v_mov_b32 v3, s69
    s_mov_b64 s[84:85], exec
    s_mov_b64 exec, 1
    buffer_store_dword v2, v3, s[40:43], 0 offen sc1
    s_mov_b64 exec, s[84:85]
Lsig_31:
    s_waitcnt lgkmcnt(0)
    s_add_u32 s100, s26, 71680
    s_add_u32 m0, s18, 8192
    s_nop 0
    buffer_load_dwordx4 v196, s[56:59], s100 offen lds
    s_add_u32 m0, s18, 9216
    s_nop 0
    buffer_load_dwordx4 v197, s[56:59], s100 offen lds
    s_add_u32 s100, s26, 86016
    s_add_u32 m0, s18, 10240
    s_nop 0
    buffer_load_dwordx4 v196, s[56:59], s100 offen lds
    s_add_u32 m0, s18, 11264
    s_nop 0
    buffer_load_dwordx4 v197, s[56:59], s100 offen lds
    s_add_u32 s100, s27, 0
    s_add_u32 m0, s18, 12288
    s_nop 0
    buffer_load_dwordx4 v196, s[56:59], s100 offen lds
    s_add_u32 m0, s18, 13312
    s_nop 0
    buffer_load_dwordx4 v197, s[56:59], s100 offen lds
    s_add_u32 s100, s27, 14336
    s_add_u32 m0, s18, 14336
    s_nop 0
    buffer_load_dwordx4 v196, s[56:59], s100 offen lds
    s_add_u32 m0, s18, 15360
    s_nop 0
    buffer_load_dwordx4 v197, s[56:59], s100 offen lds
    s_add_u32 s100, s27, 28672
    s_add_u32 m0, s18, 16384
    s_nop 0
    buffer_load_dwordx4 v196, s[56:59], s100 offen lds
    s_add_u32 m0, s18, 17408
    s_nop 0
    buffer_load_dwordx4 v197, s[56:59], s100 offen lds
    ds_read_b64_tr_b16 a[72:73], v200 offset:0
    ds_read_b64_tr_b16 a[74:75], v200 offset:1024
    ds_read_b64_tr_b16 a[76:77], v201 offset:0
    ds_read_b64_tr_b16 a[78:79], v201 offset:1024
    ds_read_b64_tr_b16 a[80:81], v200 offset:2048
    ds_read_b64_tr_b16 a[82:83], v200 offset:3072
    ds_read_b64_tr_b16 a[84:85], v201 offset:2048
    ds_read_b64_tr_b16 a[86:87], v201 offset:3072
    ds_read_b64_tr_b16 a[88:89], v200 offset:4096
    ds_read_b64_tr_b16 a[90:91], v200 offset:5120
    ds_read_b64_tr_b16 a[92:93], v201 offset:4096
    ds_read_b64_tr_b16 a[94:95], v201 offset:5120
    ds_read_b64_tr_b16 a[96:97], v202 offset:0
    ds_read_b64_tr_b16 a[98:99], v202 offset:1024
    ds_read_b64_tr_b16 a[100:101], v203 offset:0
    ds_read_b64_tr_b16 a[102:103], v203 offset:1024
    ds_read_b64_tr_b16 a[104:105], v202 offset:2048
    ds_read_b64_tr_b16 a[106:107], v202 offset:3072
    ds_read_b64_tr_b16 a[108:109], v203 offset:2048
    ds_read_b64_tr_b16 a[110:111], v203 offset:3072
    ds_read_b64_tr_b16 a[112:113], v202 offset:4096
    ds_read_b64_tr_b16 a[114:115], v202 offset:5120
    ds_read_b64_tr_b16 a[116:117], v203 offset:4096
    ds_read_b64_tr_b16 a[118:119], v203 offset:5120
    s_waitcnt lgkmcnt(0)
    s_add_u32 s100, s27, 43008
    s_add_u32 m0, s19, 0
    s_nop 0
    buffer_load_dwordx4 v196, s[56:59], s100 offen lds
    s_add_u32 m0, s19, 1024
    s_nop 0
    buffer_load_dwordx4 v197, s[56:59], s100 offen lds
    s_add_u32 s100, s27, 57344
    s_add_u32 m0, s19, 2048
    s_nop 0
    buffer_load_dwordx4 v196, s[56:59], s100 offen lds
    s_add_u32 m0, s19, 3072
    s_nop 0
    buffer_load_dwordx4 v197, s[56:59], s100 offen lds
    s_add_u32 s100, s27, 71680
    s_add_u32 m0, s19, 4096
    s_nop 0
    buffer_load_dwordx4 v196, s[56:59], s100 offen lds
    s_add_u32 m0, s19, 5120
    s_nop 0
    buffer_load_dwordx4 v197, s[56:59], s100 offen lds
    s_add_u32 s100, s27, 86016
    s_add_u32 m0, s20, 0
    s_nop 0
    buffer_load_dwordx4 v196, s[56:59], s100 offen lds
    s_add_u32 m0, s20, 1024
    s_nop 0
    buffer_load_dwordx4 v197, s[56:59], s100 offen lds
    s_waitcnt vmcnt(0)
    s_lshr_b32 s69, s79, 1
    s_mul_i32 s69, s69, 256
    s_cmp_lg_u32 s64, 0
    s_cbranch_scc1 Lpf_32
    v_mul_u32_u24 v4, 16, v1
    v_add_u32 v4, 49152, v4
    v_add_u32 v4, s69, v4
    s_mov_b64 s[84:85], exec
    s_mov_b64 exec, 0xffff
    s_mov_b32 s90, 0
Lpl_33:
    buffer_load_dword v6, v4, s[40:43], 0 offen offset:0 sc1
    s_waitcnt vmcnt(0)
    v_cmp_ne_u32 vcc, s65, v6
    s_cbranch_vccz Lpd_34
    s_sleep 1
    s_add_u32 s90, s90, 1
    s_cmp_lt_u32 s90, 50000
    s_cbranch_scc1 Lpl_33
Lpd_34:
    s_mov_b64 exec, s[84:85]
Lpf_32:
    s_barrier
    s_mul_i32 s69, s79, 224
    s_mul_i32 s70, s64, 28
    s_add_u32 s69, s69, s70
    s_lshl_b32 s69, s69, 10
    s_add_u32 s69, s69, 4194304
    v_lshl_add_u32 v4, v1, 4, s69
    s_add_u32 s70, s28, 0
    buffer_load_dwordx4 v[8:11], v4, s[40:43], s70 offen sc1
    s_add_u32 s70, s28, 1024
    buffer_load_dwordx4 v[12:15], v4, s[40:43], s70 offen sc1
    s_add_u32 s70, s28, 2048
    buffer_load_dwordx4 v[16:19], v4, s[40:43], s70 offen sc1
    s_add_u32 s70, s28, 3072
    buffer_load_dwordx4 v[20:23], v4, s[40:43], s70 offen sc1
    s_add_u32 s70, s28, 4096
    buffer_load_dwordx4 v[24:27], v4, s[40:43], s70 offen sc1
    s_add_u32 s70, s28, 5120
    buffer_load_dwordx4 v[28:31], v4, s[40:43], s70 offen sc1
    s_add_u32 s70, s28, 6144
    buffer_load_dwordx4 v[32:35], v4, s[40:43], s70 offen sc1
    s_add_u32 s70, s29, 0
    buffer_load_dwordx4 v[36:39], v4, s[40:43], s70 offen sc1
    s_add_u32 s70, s29, 1024
    buffer_load_dwordx4 v[40:43], v4, s[40:43], s70 offen sc1
    s_add_u32 s70, s29, 2048
    buffer_load_dwordx4 v[44:47], v4, s[40:43], s70 offen sc1
    ds_read_b64_tr_b16 a[120:121], v198 offset:0
    ds_read_b64_tr_b16 a[122:123], v198 offset:1024
    ds_read_b64_tr_b16 a[124:125], v199 offset:0
    ds_read_b64_tr_b16 a[126:127], v199 offset:1024
    ds_read_b64_tr_b16 a[128:129], v198 offset:2048
    ds_read_b64_tr_b16 a[130:131], v198 offset:3072
    ds_read_b64_tr_b16 a[132:133], v199 offset:2048
    ds_read_b64_tr_b16 a[134:135], v199 offset:3072
    ds_read_b64_tr_b16 a[136:137], v198 offset:4096
    ds_read_b64_tr_b16 a[138:139], v198 offset:5120
    ds_read_b64_tr_b16 a[140:141], v199 offset:4096
    ds_read_b64_tr_b16 a[142:143], v199 offset:5120
    ds_read_b64_tr_b16 a[144:145], v198 offset:6144
    ds_read_b64_tr_b16 a[146:147], v198 offset:7168
    ds_read_b64_tr_b16 a[148:149], v199 offset:6144
    ds_read_b64_tr_b16 a[150:151], v199 offset:7168
    ds_read_b64_tr_b16 a[152:153], v198 offset:8192
    ds_read_b64_tr_b16 a[154:155], v198 offset:9216
    ds_read_b64_tr_b16 a[156:157], v199 offset:8192
    ds_read_b64_tr_b16 a[158:159], v199 offset:9216
    ds_read_b64_tr_b16 a[160:161], v198 offset:10240
    ds_read_b64_tr_b16 a[162:163], v198 offset:11264
    ds_read_b64_tr_b16 a[164:165], v199 offset:10240
    ds_read_b64_tr_b16 a[166:167], v199 offset:11264
    ds_read_b64_tr_b16 a[168:169], v198 offset:12288
    ds_read_b64_tr_b16 a[170:171], v198 offset:13312
    ds_read_b64_tr_b16 a[172:173], v199 offset:12288
    ds_read_b64_tr_b16 a[174:175], v199 offset:13312
    ds_read_b64_tr_b16 a[176:177], v198 offset:14336
    ds_read_b64_tr_b16 a[178:179], v198 offset:15360
    ds_read_b64_tr_b16 a[180:181], v199 offset:14336
    ds_read_b64_tr_b16 a[182:183], v199 offset:15360
    ds_read_b64_tr_b16 a[184:185], v198 offset:16384
    ds_read_b64_tr_b16 a[186:187], v198 offset:17408
    ds_read_b64_tr_b16 a[188:189], v199 offset:16384
    ds_read_b64_tr_b16 a[190:191], v199 offset:17408
    ds_read_b64_tr_b16 a[192:193], v200 offset:0
    ds_read_b64_tr_b16 a[194:195], v200 offset:1024
    ds_read_b64_tr_b16 a[196:197], v201 offset:0
    ds_read_b64_tr_b16 a[198:199], v201 offset:1024
    ds_read_b64_tr_b16 a[200:201], v200 offset:2048
    ds_read_b64_tr_b16 a[202:203], v200 offset:3072
    ds_read_b64_tr_b16 a[204:205], v201 offset:2048
    ds_read_b64_tr_b16 a[206:207], v201 offset:3072
    ds_read_b64_tr_b16 a[208:209], v200 offset:4096
    ds_read_b64_tr_b16 a[210:211], v200 offset:5120
    ds_read_b64_tr_b16 a[212:213], v201 offset:4096
    ds_read_b64_tr_b16 a[214:215], v201 offset:5120
    ds_read_b64_tr_b16 a[216:217], v202 offset:0
    ds_read_b64_tr_b16 a[218:219], v202 offset:1024
    ds_read_b64_tr_b16 a[220:221], v203 offset:0
    ds_read_b64_tr_b16 a[222:223], v203 offset:1024
    s_waitcnt lgkmcnt(0)
    s_barrier
    s_lshl_b32 s69, s79, 1
    s_and_b32 s70, s64, 1
    s_add_u32 s69, s69, s70
    s_mul_i32 s69, s69, 28
    s_lshl_b32 s70, s80, 2
    s_add_u32 s69, s69, s70
    s_and_b32 s70, s64, 2
    s_add_u32 s69, s69, s70
    s_lshl_b32 s69, s69, 10
    s_add_u32 s69, s69, 2097152
    v_lshl_add_u32 v5, v1, 4, s69
    v_and_b32 v2, 31, v1
    v_mul_u32_u24 v6, 896, v2
    v_lshrrev_b32 v2, 5, v1
    v_lshl_add_u32 v6, v2, 4, v6
    s_lshl_b32 s69, s79, 1
    s_and_b32 s70, s64, 1
    s_add_u32 s69, s69, s70
    s_mul_i32 s69, s69, 28672
    s_lshl_b32 s70, s80, 7
    s_add_u32 s69, s69, s70
    s_and_b32 s70, s64, 2
    s_lshl_b32 s70, s70, 5
    s_add_u32 s69, s69, s70
    v_add_u32 v6, s69, v6
    s_lshl_b32 s69, s64, 12
    v_lshl_add_u32 v120, v1, 4, s69
    s_waitcnt vmcnt(9)
    v_mfma_f32_32x32x16_bf16 v[48:63], a[0:3], v[8:11], 0
    v_mfma_f32_32x32x16_bf16 v[80:95], a[4:7], v[8:11], 0
    s_add_u32 s70, s29, 3072
    buffer_load_dwordx4 v[8:11], v4, s[40:43], s70 offen sc1
    s_waitcnt vmcnt(9)
    v_mfma_f32_32x32x16_bf16 v[48:63], a[8:11], v[12:15], v[48:63]
    v_mfma_f32_32x32x16_bf16 v[80:95], a[12:15], v[12:15], v[80:95]
    s_add_u32 s70, s29, 4096
    buffer_load_dwordx4 v[12:15], v4, s[40:43], s70 offen sc1
    s_waitcnt vmcnt(9)
    v_mfma_f32_32x32x16_bf16 v[48:63], a[16:19], v[16:19], v[48:63]
    v_mfma_f32_32x32x16_bf16 v[80:95], a[20:23], v[16:19], v[80:95]
    s_add_u32 s70, s29, 5120
    buffer_load_dwordx4 v[16:19], v4, s[40:43], s70 offen sc1
    s_waitcnt vmcnt(9)
    v_mfma_f32_32x32x16_bf16 v[48:63], a[24:27], v[20:23], v[48:63]
    v_mfma_f32_32x32x16_bf16 v[80:95], a[28:31], v[20:23], v[80:95]
    s_add_u32 s70, s29, 6144
    buffer_load_dwordx4 v[20:23], v4, s[40:43], s70 offen sc1
    s_waitcnt vmcnt(9)
    v_mfma_f32_32x32x16_bf16 v[48:63], a[32:35], v[24:27], v[48:63]
    v_mfma_f32_32x32x16_bf16 v[80:95], a[36:39], v[24:27], v[80:95]
    s_add_u32 s70, s30, 0
    buffer_load_dwordx4 v[24:27], v4, s[40:43], s70 offen sc1
    s_waitcnt vmcnt(9)
    v_mfma_f32_32x32x16_bf16 v[48:63], a[40:43], v[28:31], v[48:63]
    v_mfma_f32_32x32x16_bf16 v[80:95], a[44:47], v[28:31], v[80:95]
    s_add_u32 s70, s30, 1024
    buffer_load_dwordx4 v[28:31], v4, s[40:43], s70 offen sc1
    s_waitcnt vmcnt(9)
    v_mfma_f32_32x32x16_bf16 v[48:63], a[48:51], v[32:35], v[48:63]
    v_mfma_f32_32x32x16_bf16 v[80:95], a[52:55], v[32:35], v[80:95]
    s_add_u32 s70, s30, 2048
    buffer_load_dwordx4 v[32:35], v4, s[40:43], s70 offen sc1
    s_waitcnt vmcnt(9)
    v_mfma_f32_32x32x16_bf16 v[48:63], a[56:59], v[36:39], v[48:63]
    v_mfma_f32_32x32x16_bf16 v[80:95], a[60:63], v[36:39], v[80:95]
    s_add_u32 s70, s30, 3072
    buffer_load_dwordx4 v[36:39], v4, s[40:43], s70 offen sc1
    s_waitcnt vmcnt(9)
    v_mfma_f32_32x32x16_bf16 v[48:63], a[64:67], v[40:43], v[48:63]
    v_mfma_f32_32x32x16_bf16 v[80:95], a[68:71], v[40:43], v[80:95]
    s_add_u32 s70, s30, 4096
    buffer_load_dwordx4 v[40:43], v4, s[40:43], s70 offen sc1
    s_waitcnt vmcnt(9)
    v_mfma_f32_32x32x16_bf16 v[48:63], a[72:75], v[44:47], v[48:63]
    v_mfma_f32_32x32x16_bf16 v[80:95], a[76:79], v[44:47], v[80:95]
    s_add_u32 s70, s30, 5120
    buffer_load_dwordx4 v[44:47], v4, s[40:43], s70 offen sc1
    s_waitcnt vmcnt(9)
    v_mfma_f32_32x32x16_bf16 v[48:63], a[80:83], v[8:11], v[48:63]
    v_mfma_f32_32x32x16_bf16 v[80:95], a[84:87], v[8:11], v[80:95]
    s_add_u32 s70, s30, 6144
    buffer_load_dwordx4 v[8:11], v4, s[40:43], s70 offen sc1
    s_waitcnt vmcnt(9)
    v_mfma_f32_32x32x16_bf16 v[48:63], a[88:91], v[12:15], v[48:63]
    v_mfma_f32_32x32x16_bf16 v[80:95], a[92:95], v[12:15], v[80:95]
    s_add_u32 s70, s31, 0
    buffer_load_dwordx4 v[12:15], v4, s[40:43], s70 offen sc1
    s_waitcnt vmcnt(9)
    v_mfma_f32_32x32x16_bf16 v[48:63], a[96:99], v[16:19], v[48:63]
    v_mfma_f32_32x32x16_bf16 v[80:95], a[100:103], v[16:19], v[80:95]
    s_add_u32 s70, s31, 1024
    buffer_load_dwordx4 v[16:19], v4, s[40:43], s70 offen sc1
    s_waitcnt vmcnt(9)
    v_mfma_f32_32x32x16_bf16 v[48:63], a[104:107], v[20:23], v[48:63]
    v_mfma_f32_32x32x16_bf16 v[80:95], a[108:111], v[20:23], v[80:95]
    s_add_u32 s70, s31, 2048
    buffer_load_dwordx4 v[20:23], v4, s[40:43], s70 offen sc1
    s_waitcnt vmcnt(9)
    v_mfma_f32_32x32x16_bf16 v[48:63], a[112:115], v[24:27], v[48:63]
    v_mfma_f32_32x32x16_bf16 v[80:95], a[116:119], v[24:27], v[80:95]
    s_add_u32 s70, s31, 3072
    buffer_load_dwordx4 v[24:27], v4, s[40:43], s70 offen sc1
    s_waitcnt vmcnt(9)
    v_mfma_f32_32x32x16_bf16 v[48:63], a[120:123], v[28:31], v[48:63]
    v_mfma_f32_32x32x16_bf16 v[80:95], a[124:127], v[28:31], v[80:95]
    s_add_u32 s70, s31, 4096
    buffer_load_dwordx4 v[28:31], v4, s[40:43], s70 offen sc1
    s_waitcnt vmcnt(9)
    v_mfma_f32_32x32x16_bf16 v[48:63], a[128:131], v[32:35], v[48:63]
    v_mfma_f32_32x32x16_bf16 v[80:95], a[132:135], v[32:35], v[80:95]
    s_add_u32 s70, s31, 5120
    buffer_load_dwordx4 v[32:35], v4, s[40:43], s70 offen sc1
    s_waitcnt vmcnt(9)
    v_mfma_f32_32x32x16_bf16 v[48:63], a[136:139], v[36:39], v[48:63]
    v_mfma_f32_32x32x16_bf16 v[80:95], a[140:143], v[36:39], v[80:95]
    s_add_u32 s70, s31, 6144
    buffer_load_dwordx4 v[36:39], v4, s[40:43], s70 offen sc1
    s_waitcnt vmcnt(9)
    v_mfma_f32_32x32x16_bf16 v[48:63], a[144:147], v[40:43], v[48:63]
    v_mfma_f32_32x32x16_bf16 v[80:95], a[148:151], v[40:43], v[80:95]
    s_add_u32 s70, s28, 114688
    buffer_load_dwordx4 v[40:43], v4, s[40:43], s70 offen sc1
    s_waitcnt vmcnt(9)
    v_mfma_f32_32x32x16_bf16 v[48:63], a[152:155], v[44:47], v[48:63]
    v_mfma_f32_32x32x16_bf16 v[80:95], a[156:159], v[44:47], v[80:95]
    s_add_u32 s70, s28, 115712
    buffer_load_dwordx4 v[44:47], v4, s[40:43], s70 offen sc1
    s_waitcnt vmcnt(9)
    v_mfma_f32_32x32x16_bf16 v[48:63], a[160:163], v[8:11], v[48:63]
    v_mfma_f32_32x32x16_bf16 v[80:95], a[164:167], v[8:11], v[80:95]
    s_add_u32 s70, s28, 116736
    buffer_load_dwordx4 v[8:11], v4, s[40:43], s70 offen sc1
    s_waitcnt vmcnt(9)
    v_mfma_f32_32x32x16_bf16 v[48:63], a[168:171], v[12:15], v[48:63]
    v_mfma_f32_32x32x16_bf16 v[80:95], a[172:175], v[12:15], v[80:95]
    s_add_u32 s70, s28, 117760
    buffer_load_dwordx4 v[12:15], v4, s[40:43], s70 offen sc1
    s_waitcnt vmcnt(9)
    v_mfma_f32_32x32x16_bf16 v[48:63], a[176:179], v[16:19], v[48:63]
    v_mfma_f32_32x32x16_bf16 v[80:95], a[180:183], v[16:19], v[80:95]
    s_add_u32 s70, s28, 118784
    buffer_load_dwordx4 v[16:19], v4, s[40:43], s70 offen sc1
    s_waitcnt vmcnt(9)
    v_mfma_f32_32x32x16_bf16 v[48:63], a[184:187], v[20:23], v[48:63]
    v_mfma_f32_32x32x16_bf16 v[80:95], a[188:191], v[20:23], v[80:95]
    s_add_u32 s70, s28, 119808
    buffer_load_dwordx4 v[20:23], v4, s[40:43], s70 offen sc1
    s_waitcnt vmcnt(9)
    v_mfma_f32_32x32x16_bf16 v[48:63], a[192:195], v[24:27], v[48:63]
    v_mfma_f32_32x32x16_bf16 v[80:95], a[196:199], v[24:27], v[80:95]
    s_add_u32 s70, s28, 120832
    buffer_load_dwordx4 v[24:27], v4, s[40:43], s70 offen sc1
    s_waitcnt vmcnt(9)
    v_mfma_f32_32x32x16_bf16 v[48:63], a[200:203], v[28:31], v[48:63]
    v_mfma_f32_32x32x16_bf16 v[80:95], a[204:207], v[28:31], v[80:95]
    s_add_u32 s70, s29, 114688
    buffer_load_dwordx4 v[28:31], v4, s[40:43], s70 offen sc1
    s_waitcnt vmcnt(9)
    v_mfma_f32_32x32x16_bf16 v[48:63], a[208:211], v[32:35], v[48:63]
    v_mfma_f32_32x32x16_bf16 v[80:95], a[212:215], v[32:35], v[80:95]
    s_add_u32 s70, s29, 115712
    buffer_load_dwordx4 v[32:35], v4, s[40:43], s70 offen sc1
    s_waitcnt vmcnt(9)
    v_mfma_f32_32x32x16_bf16 v[48:63], a[216:219], v[36:39], v[48:63]
    v_mfma_f32_32x32x16_bf16 v[80:95], a[220:223], v[36:39], v[80:95]
    s_add_u32 s70, s29, 116736
    buffer_load_dwordx4 v[36:39], v4, s[40:43], s70 offen sc1
    s_waitcnt vmcnt(9)
    v_mfma_f32_32x32x16_bf16 v[64:79], a[0:3], v[40:43], 0
    v_mfma_f32_32x32x16_bf16 v[96:111], a[4:7], v[40:43], 0
    s_add_u32 s70, s29, 117760
    buffer_load_dwordx4 v[40:43], v4, s[40:43], s70 offen sc1
    s_waitcnt vmcnt(9)
    v_mfma_f32_32x32x16_bf16 v[64:79], a[8:11], v[44:47], v[64:79]
    v_mfma_f32_32x32x16_bf16 v[96:111], a[12:15], v[44:47], v[96:111]
    s_add_u32 s70, s29, 118784
    buffer_load_dwordx4 v[44:47], v4, s[40:43], s70 offen sc1
    s_waitcnt vmcnt(9)
    v_mfma_f32_32x32x16_bf16 v[64:79], a[16:19], v[8:11], v[64:79]
    v_mfma_f32_32x32x16_bf16 v[96:111], a[20:23], v[8:11], v[96:111]
    s_add_u32 s70, s29, 119808
    buffer_load_dwordx4 v[8:11], v4, s[40:43], s70 offen sc1
    s_waitcnt vmcnt(9)
    v_mfma_f32_32x32x16_bf16 v[64:79], a[24:27], v[12:15], v[64:79]
    v_mfma_f32_32x32x16_bf16 v[96:111], a[28:31], v[12:15], v[96:111]
    s_add_u32 s70, s29, 120832
    buffer_load_dwordx4 v[12:15], v4, s[40:43], s70 offen sc1
    s_waitcnt vmcnt(9)
    v_mfma_f32_32x32x16_bf16 v[64:79], a[32:35], v[16:19], v[64:79]
    v_mfma_f32_32x32x16_bf16 v[96:111], a[36:39], v[16:19], v[96:111]
    s_add_u32 s70, s30, 114688
    buffer_load_dwordx4 v[16:19], v4, s[40:43], s70 offen sc1
    s_waitcnt vmcnt(9)
    v_mfma_f32_32x32x16_bf16 v[64:79], a[40:43], v[20:23], v[64:79]
    ds_write_b128 v120, v[48:51] offset:0
    v_mfma_f32_32x32x16_bf16 v[96:111], a[44:47], v[20:23], v[96:111]
    s_add_u32 s70, s30, 115712
    buffer_load_dwordx4 v[20:23], v4, s[40:43], s70 offen sc1
    s_waitcnt vmcnt(9)
    v_mfma_f32_32x32x16_bf16 v[64:79], a[48:51], v[24:27], v[64:79]
    v_mfma_f32_32x32x16_bf16 v[96:111], a[52:55], v[24:27], v[96:111]
    s_add_u32 s70, s30, 116736
    buffer_load_dwordx4 v[24:27], v4, s[40:43], s70 offen sc1
    s_waitcnt vmcnt(9)
    v_mfma_f32_32x32x16_bf16 v[64:79], a[56:59], v[28:31], v[64:79]
    v_mfma_f32_32x32x16_bf16 v[96:111], a[60:63], v[28:31], v[96:111]
    s_add_u32 s70, s30, 117760
    buffer_load_dwordx4 v[28:31], v4, s[40:43], s70 offen sc1
    ds_write_b128 v120, v[52:55] offset:1024
    s_waitcnt vmcnt(9)
    v_mfma_f32_32x32x16_bf16 v[64:79], a[64:67], v[32:35], v[64:79]
    v_mfma_f32_32x32x16_bf16 v[96:111], a[68:71], v[32:35], v[96:111]
    s_add_u32 s70, s30, 118784
    buffer_load_dwordx4 v[32:35], v4, s[40:43], s70 offen sc1
    s_waitcnt vmcnt(9)
    v_mfma_f32_32x32x16_bf16 v[64:79], a[72:75], v[36:39], v[64:79]
    v_mfma_f32_32x32x16_bf16 v[96:111], a[76:79], v[36:39], v[96:111]
    s_add_u32 s70, s30, 119808
    buffer_load_dwordx4 v[36:39], v4, s[40:43], s70 offen sc1
    s_waitcnt vmcnt(9)
    v_mfma_f32_32x32x16_bf16 v[64:79], a[80:83], v[40:43], v[64:79]
    ds_write_b128 v120, v[56:59] offset:2048
    v_mfma_f32_32x32x16_bf16 v[96:111], a[84:87], v[40:43], v[96:111]
    s_add_u32 s70, s30, 120832
    buffer_load_dwordx4 v[40:43], v4, s[40:43], s70 offen sc1
    s_waitcnt vmcnt(9)
    v_mfma_f32_32x32x16_bf16 v[64:79], a[88:91], v[44:47], v[64:79]
    v_mfma_f32_32x32x16_bf16 v[96:111], a[92:95], v[44:47], v[96:111]
    s_add_u32 s70, s31, 114688
    buffer_load_dwordx4 v[44:47], v4, s[40:43], s70 offen sc1
    s_waitcnt vmcnt(9)
    v_mfma_f32_32x32x16_bf16 v[64:79], a[96:99], v[8:11], v[64:79]
    ds_write_b128 v120, v[60:63] offset:3072
    v_mfma_f32_32x32x16_bf16 v[96:111], a[100:103], v[8:11], v[96:111]
    s_add_u32 s70, s31, 115712
    buffer_load_dwordx4 v[8:11], v4, s[40:43], s70 offen sc1
    s_waitcnt vmcnt(9)
    v_mfma_f32_32x32x16_bf16 v[64:79], a[104:107], v[12:15], v[64:79]
    v_mfma_f32_32x32x16_bf16 v[96:111], a[108:111], v[12:15], v[96:111]
    s_add_u32 s70, s31, 116736
    buffer_load_dwordx4 v[12:15], v4, s[40:43], s70 offen sc1
    s_waitcnt vmcnt(9)
    v_mfma_f32_32x32x16_bf16 v[64:79], a[112:115], v[16:19], v[64:79]
    v_mfma_f32_32x32x16_bf16 v[96:111], a[116:119], v[16:19], v[96:111]
    s_add_u32 s70, s31, 117760
    buffer_load_dwordx4 v[16:19], v4, s[40:43], s70 offen sc1
    ds_write_b128 v120, v[80:83] offset:32768
    s_waitcnt vmcnt(9)
    v_mfma_f32_32x32x16_bf16 v[64:79], a[120:123], v[20:23], v[64:79]
    v_mfma_f32_32x32x16_bf16 v[96:111], a[124:127], v[20:23], v[96:111]
    s_add_u32 s70, s31, 118784
    buffer_load_dwordx4 v[20:23], v4, s[40:43], s70 offen sc1
    s_waitcnt vmcnt(9)
    v_mfma_f32_32x32x16_bf16 v[64:79], a[128:131], v[24:27], v[64:79]
    v_mfma_f32_32x32x16_bf16 v[96:111], a[132:135], v[24:27], v[96:111]
    s_add_u32 s70, s31, 119808
    buffer_load_dwordx4 v[24:27], v4, s[40:43], s70 offen sc1
    s_waitcnt vmcnt(9)
    v_mfma_f32_32x32x16_bf16 v[64:79], a[136:139], v[28:31], v[64:79]
    ds_write_b128 v120, v[84:87] offset:33792
    v_mfma_f32_32x32x16_bf16 v[96:111], a[140:143], v[28:31], v[96:111]
    s_add_u32 s70, s31, 120832
    buffer_load_dwordx4 v[28:31], v4, s[40:43], s70 offen sc1
    s_waitcnt vmcnt(9)
    v_mfma_f32_32x32x16_bf16 v[64:79], a[144:147], v[32:35], v[64:79]
    v_mfma_f32_32x32x16_bf16 v[96:111], a[148:151], v[32:35], v[96:111]
    buffer_load_dwordx4 v[112:115], v5, s[40:43], 0 offen offset:0 sc1
    buffer_load_dwordx4 v[116:119], v5, s[40:43], 0 offen offset:1024 sc1
    s_waitcnt vmcnt(10)
    v_mfma_f32_32x32x16_bf16 v[64:79], a[152:155], v[36:39], v[64:79]
    v_mfma_f32_32x32x16_bf16 v[96:111], a[156:159], v[36:39], v[96:111]
    ds_write_b128 v120, v[88:91] offset:34816
    s_waitcnt vmcnt(9)
    v_mfma_f32_32x32x16_bf16 v[64:79], a[160:163], v[40:43], v[64:79]
    v_mfma_f32_32x32x16_bf16 v[96:111], a[164:167], v[40:43], v[96:111]
    s_waitcnt vmcnt(8)
    v_mfma_f32_32x32x16_bf16 v[64:79], a[168:171], v[44:47], v[64:79]
    v_mfma_f32_32x32x16_bf16 v[96:111], a[172:175], v[44:47], v[96:111]
    ds_write_b128 v120, v[92:95] offset:35840
    s_waitcnt vmcnt(7)
    v_mfma_f32_32x32x16_bf16 v[64:79], a[176:179], v[8:11], v[64:79]
    v_mfma_f32_32x32x16_bf16 v[96:111], a[180:183], v[8:11], v[96:111]
    s_waitcnt vmcnt(6)
    v_mfma_f32_32x32x16_bf16 v[64:79], a[184:187], v[12:15], v[64:79]
    v_mfma_f32_32x32x16_bf16 v[96:111], a[188:191], v[12:15], v[96:111]
    s_waitcnt vmcnt(5)
    v_mfma_f32_32x32x16_bf16 v[64:79], a[192:195], v[16:19], v[64:79]
    v_mfma_f32_32x32x16_bf16 v[96:111], a[196:199], v[16:19], v[96:111]
    s_waitcnt vmcnt(4)
    v_mfma_f32_32x32x16_bf16 v[64:79], a[200:203], v[20:23], v[64:79]
    v_mfma_f32_32x32x16_bf16 v[96:111], a[204:207], v[20:23], v[96:111]
    s_waitcnt vmcnt(3)
    v_mfma_f32_32x32x16_bf16 v[64:79], a[208:211], v[24:27], v[64:79]
    v_mfma_f32_32x32x16_bf16 v[96:111], a[212:215], v[24:27], v[96:111]
    s_waitcnt vmcnt(2)
    v_mfma_f32_32x32x16_bf16 v[64:79], a[216:219], v[28:31], v[64:79]
    v_mfma_f32_32x32x16_bf16 v[96:111], a[220:223], v[28:31], v[96:111]
    s_nop 10
    ds_write_b128 v120, v[64:67] offset:16384
    ds_write_b128 v120, v[68:71] offset:17408
    ds_write_b128 v120, v[72:75] offset:18432
    ds_write_b128 v120, v[76:79] offset:19456
    ds_write_b128 v120, v[96:99] offset:49152
    ds_write_b128 v120, v[100:103] offset:50176
    ds_write_b128 v120, v[104:107] offset:51200
    ds_write_b128 v120, v[108:111] offset:52224
    s_waitcnt lgkmcnt(0)
    s_barrier
    s_lshl_b32 s69, s64, 14
    v_lshl_add_u32 v120, v1, 4, s69
    ds_read_b128 v[124:127], v120 offset:0
    ds_read_b128 v[128:131], v120 offset:1024
    ds_read_b128 v[132:135], v120 offset:2048
    ds_read_b128 v[136:139], v120 offset:3072
    ds_read_b128 v[140:143], v120 offset:4096
    ds_read_b128 v[144:147], v120 offset:5120
    ds_read_b128 v[148:151], v120 offset:6144
    ds_read_b128 v[152:155], v120 offset:7168
    ds_read_b128 v[156:159], v120 offset:8192
    ds_read_b128 v[160:163], v120 offset:9216
    ds_read_b128 v[164:167], v120 offset:10240
    ds_read_b128 v[168:171], v120 offset:11264
    ds_read_b128 v[172:175], v120 offset:12288
    ds_read_b128 v[176:179], v120 offset:13312
    ds_read_b128 v[180:183], v120 offset:14336
    ds_read_b128 v[184:187], v120 offset:15360
    s_waitcnt lgkmcnt(8)
    v_pk_add_f32 v[124:125], v[124:125], v[140:141]
    v_pk_add_f32 v[126:127], v[126:127], v[142:143]
    v_pk_add_f32 v[128:129], v[128:129], v[144:145]
    v_pk_add_f32 v[130:131], v[130:131], v[146:147]
    v_pk_add_f32 v[132:133], v[132:133], v[148:149]
    v_pk_add_f32 v[134:135], v[134:135], v[150:151]
    v_pk_add_f32 v[136:137], v[136:137], v[152:153]
    v_pk_add_f32 v[138:139], v[138:139], v[154:155]
    s_waitcnt lgkmcnt(4)
    v_pk_add_f32 v[124:125], v[124:125], v[156:157]
    v_pk_add_f32 v[126:127], v[126:127], v[158:159]
    v_pk_add_f32 v[128:129], v[128:129], v[160:161]
    v_pk_add_f32 v[130:131], v[130:131], v[162:163]
    v_pk_add_f32 v[132:133], v[132:133], v[164:165]
    v_pk_add_f32 v[134:135], v[134:135], v[166:167]
    v_pk_add_f32 v[136:137], v[136:137], v[168:169]
    v_pk_add_f32 v[138:139], v[138:139], v[170:171]
    s_waitcnt lgkmcnt(0)
    v_pk_add_f32 v[124:125], v[124:125], v[172:173]
    v_pk_add_f32 v[126:127], v[126:127], v[174:175]
    v_pk_add_f32 v[128:129], v[128:129], v[176:177]
    v_pk_add_f32 v[130:131], v[130:131], v[178:179]
    v_pk_add_f32 v[132:133], v[132:133], v[180:181]
    v_pk_add_f32 v[134:135], v[134:135], v[182:183]
    v_pk_add_f32 v[136:137], v[136:137], v[184:185]
    v_pk_add_f32 v[138:139], v[138:139], v[186:187]
    s_waitcnt vmcnt(0)
    v_cvt_pk_bf16_f32 v8, v124, v125
    v_cvt_pk_bf16_f32 v9, v126, v127
    v_cvt_pk_bf16_f32 v10, v128, v129
    v_cvt_pk_bf16_f32 v11, v130, v131
    v_cvt_pk_bf16_f32 v12, v132, v133
    v_cvt_pk_bf16_f32 v13, v134, v135
    v_cvt_pk_bf16_f32 v14, v136, v137
    v_cvt_pk_bf16_f32 v15, v138, v139
    v_lshlrev_b32 v140, 16, v8
    v_and_b32 v141, 0xffff0000, v8
    v_lshlrev_b32 v156, 16, v112
    v_and_b32 v157, 0xffff0000, v112
    v_lshlrev_b32 v142, 16, v9
    v_and_b32 v143, 0xffff0000, v9
    v_lshlrev_b32 v158, 16, v113
    v_and_b32 v159, 0xffff0000, v113
    v_lshlrev_b32 v144, 16, v10
    v_and_b32 v145, 0xffff0000, v10
    v_lshlrev_b32 v160, 16, v114
    v_and_b32 v161, 0xffff0000, v114
    v_lshlrev_b32 v146, 16, v11
    v_and_b32 v147, 0xffff0000, v11
    v_lshlrev_b32 v162, 16, v115
    v_and_b32 v163, 0xffff0000, v115
    v_lshlrev_b32 v148, 16, v12
    v_and_b32 v149, 0xffff0000, v12
    v_lshlrev_b32 v164, 16, v116
    v_and_b32 v165, 0xffff0000, v116
    v_lshlrev_b32 v150, 16, v13
    v_and_b32 v151, 0xffff0000, v13
    v_lshlrev_b32 v166, 16, v117
    v_and_b32 v167, 0xffff0000, v117
    v_lshlrev_b32 v152, 16, v14
    v_and_b32 v153, 0xffff0000, v14
    v_lshlrev_b32 v168, 16, v118
    v_and_b32 v169, 0xffff0000, v118
    v_lshlrev_b32 v154, 16, v15
    v_and_b32 v155, 0xffff0000, v15
    v_lshlrev_b32 v170, 16, v119
    v_and_b32 v171, 0xffff0000, v119
    v_pk_add_f32 v[140:141], v[140:141], v[156:157]
    v_pk_add_f32 v[142:143], v[142:143], v[158:159]
    v_pk_add_f32 v[144:145], v[144:145], v[160:161]
    v_pk_add_f32 v[146:147], v[146:147], v[162:163]
    v_pk_add_f32 v[148:149], v[148:149], v[164:165]
    v_pk_add_f32 v[150:151], v[150:151], v[166:167]
    v_pk_add_f32 v[152:153], v[152:153], v[168:169]
    v_pk_add_f32 v[154:155], v[154:155], v[170:171]
    v_cvt_pk_bf16_f32 v8, v140, v141
    v_cvt_pk_bf16_f32 v9, v142, v143
    v_cvt_pk_bf16_f32 v10, v144, v145
    v_cvt_pk_bf16_f32 v11, v146, v147
    v_cvt_pk_bf16_f32 v12, v148, v149
    v_cvt_pk_bf16_f32 v13, v150, v151
    v_cvt_pk_bf16_f32 v14, v152, v153
    v_cvt_pk_bf16_f32 v15, v154, v155
    v_permlane32_swap_b32 v8, v10
    v_permlane32_swap_b32 v9, v11
    v_permlane32_swap_b32 v12, v14
    v_permlane32_swap_b32 v13, v15
    buffer_store_dwordx4 v[8:11], v6, s[60:63], 0 offen offset:0
    buffer_store_dwordx4 v[12:15], v6, s[60:63], 0 offen offset:32
L_end:
    s_endpgm
.section .rodata,"a"
.p2align 6
.amdhsa_kernel sequential_preLN__ssm_conv_s4__swiglu_ffn__prompt_kernel
  .amdhsa_next_free_vgpr 512
  .amdhsa_next_free_sgpr 102
  .amdhsa_accum_offset 256
  .amdhsa_group_segment_fixed_size 0
  .amdhsa_kernarg_size 128
  .amdhsa_user_sgpr_count 2
  .amdhsa_user_sgpr_kernarg_segment_ptr 1
  .amdhsa_system_sgpr_workgroup_id_x 1
  .amdhsa_float_denorm_mode_32 3
.end_amdhsa_kernel
```
